```python
import torch

def _softmax(x, axis=-1):
    return torch.softmax(x, dim=axis)
def _gelu(x):
    return torch.nn.functional.gelu(x, approximate="tanh")
def _silu(x):
    return torch.nn.functional.silu(x)
def _sigmoid(x):
    return torch.sigmoid(x)
def _layernorm(x, axis=-1, eps=1e-5):
    m = x.mean(dim=axis, keepdim=True)
    v = x.var(dim=axis, keepdim=True, unbiased=False)
    return (x - m) / torch.sqrt(v + eps)
def _scatter_add(tgt, idx, src, axis=0):
    return tgt.clone().index_add_(axis, idx, src)
def _segment_sum(src, seg, n):
    out = torch.zeros((n,) + src.shape[1:], dtype=src.dtype)
    return out.index_add_(0, seg, src)
def _pad(x, pw):
    flat = tuple(v for pair in reversed(pw) for v in pair)
    return torch.nn.functional.pad(x, flat)

kernel_name = 'interleave_layers__sliding_block_cached__glu_gated_bilinear__decode'

def setup_inputs():

    _w = (lambda a: (lambda t: t.to(torch.bfloat16) if t.is_floating_point() else t)(torch.as_tensor(a)))
    def _A_setup():
        B, Sq, D = 1, 1, 640
        Hq, Hkv, Sk, Dh = 32, 32, 8192, 192
        assert Hq % Hkv == 0, (Hq, Hkv)
        return {
            "x": _w((lambda *s: torch.randn(*s, dtype=torch.bfloat16) * 0.05)(B, Sq, D)),
            "k_cache": _w((lambda *s: torch.randn(*s, dtype=torch.bfloat16) * 0.8)(B, Hkv, Sk, Dh)),
            "v_cache": _w((lambda *s: torch.randn(*s, dtype=torch.bfloat16) * 0.8)(B, Hkv, Sk, Dh)),
            "wq": _w((lambda *s: torch.randn(*s, dtype=torch.bfloat16) * 0.8)(D, Hq * Dh) * (D ** -0.5)),
            "wo": _w((lambda *s: torch.randn(*s, dtype=torch.bfloat16) * 0.8)(Hq * Dh, D) * ((Hq * Dh) ** -0.5)),
        }
    _A_in = _A_setup()

    def _B_setup():
        B, S, D, F = 1, 1, 640, 1536
        return {
            "x": _w((lambda *s: torch.randn(*s, dtype=torch.bfloat16) * 0.05)(B, S, D)),
            "w_gate": _w((lambda *s: torch.randn(*s, dtype=torch.bfloat16) * 0.4)(D, F) * (D ** -0.5)),
            "w_up": _w((lambda *s: torch.randn(*s, dtype=torch.bfloat16) * 0.4)(D, F) * (D ** -0.5)),
            "w_down": _w((lambda *s: torch.randn(*s, dtype=torch.bfloat16) * 0.4)(F, D) * (F ** -0.5)),
        }
    _B_in = _B_setup()

    return {
        "A_x": _A_in["x"],
        "A_k_cache": _A_in["k_cache"],
        "A_v_cache": _A_in["v_cache"],
        "A_wq": _A_in["wq"],
        "A_wo": _A_in["wo"],
        "B_x": _B_in["x"],
        "B_w_gate": _B_in["w_gate"],
        "B_w_up": _B_in["w_up"],
        "B_w_down": _B_in["w_down"],
    }

def reference(A_x, A_k_cache, A_v_cache, A_wq, A_wo, B_x, B_w_gate, B_w_up, B_w_down):
    def _A_ref(x, k_cache, v_cache, wq, wo):
        B, Sq, D = x.shape
        Hq, Dh = 32, 192
        Hkv, Sk = k_cache.shape[1], k_cache.shape[2]
        W = min(4096, max(256, Sk // 4))
        rep = Hq // Hkv
        q = (lambda x, *d: x.permute(*d))((x @ wq).reshape(B, Sq, Hq, Dh), 0, 2, 1, 3)
        k = (lambda x, n, axis: torch.repeat_interleave(x, n, dim=axis))(k_cache[:, :, Sk - W:, :], rep, axis=1)
        v = (lambda x, n, axis: torch.repeat_interleave(x, n, dim=axis))(v_cache[:, :, Sk - W:, :], rep, axis=1)
        scores = torch.einsum("bhqd,bhkd->bhqk", q, k) * (Dh ** -0.5)
        p = _softmax(scores, axis=-1)
        o = torch.einsum("bhqk,bhkd->bhqd", p, v)
        return (lambda x, *d: x.permute(*d))(o, 0, 2, 1, 3).reshape(B, Sq, Hq * Dh) @ wo

    def _B_ref(x, w_gate, w_up, w_down):
        g = torch.einsum("bsd,df->bsf", x, w_gate)
        u = torch.einsum("bsd,df->bsf", x, w_up)
        h = g * u
        return torch.einsum("bsf,fd->bsd", h, w_down)

    x = A_x
    x = x + _A_ref(_layernorm(x, axis=-1), A_k_cache, A_v_cache, A_wq, A_wo)
    x = x + _B_ref(_layernorm(x, axis=-1), B_w_gate, B_w_up, B_w_down)
    x = x + _A_ref(_layernorm(x, axis=-1), A_k_cache, A_v_cache, A_wq, A_wo)
    x = x + _B_ref(_layernorm(x, axis=-1), B_w_gate, B_w_up, B_w_down)
    return x
```

```asm
; @launch grid=(256,1,1) block=(512,1,1) lds=163840
.amdgcn_target "amdgcn-amd-amdhsa--gfx950"
.text
.globl interleave_layers__sliding_block_cached__glu_gated_bilinear__decode_kernel
.p2align 8
.type interleave_layers__sliding_block_cached__glu_gated_bilinear__decode_kernel,@function
interleave_layers__sliding_block_cached__glu_gated_bilinear__decode_kernel:
    s_cmp_ge_u32 s2, 256
    s_cbranch_scc1 L_end
    s_load_dwordx16 s[64:79], s[0:1], 0
    s_load_dwordx8 s[80:87], s[0:1], 64
    v_readfirstlane_b32 s6, v0
    s_and_b32 s4, s2, 7
    s_lshl_b32 s4, s4, 2
    s_bfe_u32 s3, s2, 0x20003
    s_or_b32 s4, s4, s3
    s_lshr_b32 s5, s2, 5
    s_lshr_b32 s6, s6, 6
    v_and_b32 v1, 63, v0
    v_lshrrev_b32 v2, 4, v1
    v_and_b32_e64 v3, 15, v1
    s_lshl_b32 s45, s4, 16
    s_lshl_b32 s3, s5, 13
    s_add_u32 s44, s45, s3
    s_mul_i32 s62, s5, 160
    v_add_u32_e64 v30, 0, v1
    v_mul_u32_u24 v31, 2731, v30
    v_lshrrev_b32 v31, 16, v31
    v_mul_u32_u24 v32, 24, v31
    v_sub_u32 v32, v30, v32
    v_and_b32 v33, 6, v31
    v_xor_b32 v33, v33, v32
    v_lshlrev_b32 v33, 4, v33
    v_mul_u32_u24 v34, 384, v31
    v_add_u32_e64 v74, v34, v33
    v_mul_u32_u24 v34, 12288, v31
    v_add_u32 v24, v34, v33
    v_add_u32 v30, 64, v1
    v_mul_u32_u24 v31, 2731, v30
    v_lshrrev_b32 v31, 16, v31
    v_mul_u32_u24 v32, 24, v31
    v_sub_u32 v32, v30, v32
    v_and_b32 v33, 6, v31
    v_xor_b32 v33, v33, v32
    v_lshlrev_b32 v33, 4, v33
    v_mul_u32_u24 v34, 384, v31
    v_add_u32_e64 v75, v34, v33
    v_mul_u32_u24 v34, 12288, v31
    v_add_u32_e64 v25, v34, v33
    v_add_u32 v30, 128, v1
    v_mul_u32_u24 v31, 2731, v30
    v_lshrrev_b32 v31, 16, v31
    v_mul_u32_u24 v32, 24, v31
    v_sub_u32 v32, v30, v32
    v_and_b32 v33, 6, v31
    v_xor_b32 v33, v33, v32
    v_lshlrev_b32 v33, 4, v33
    v_mul_u32_u24 v34, 384, v31
    v_add_u32_e64 v76, v34, v33
    v_mul_u32_u24 v34, 12288, v31
    v_add_u32_e64 v26, v34, v33
    s_mul_i32 s60, s4, 3145728
    s_mul_i32 s57, s5, 98304
    s_add_u32 s60, s60, s57
    s_add_u32 s60, s60, 2359296
    s_mul_i32 s61, s5, 983040
    s_mul_i32 s57, s4, 384
    s_add_u32 s61, s61, s57
    s_cmp_lg_u32 s6, 0
    s_cbranch_scc1 L_fz_1
    v_mov_b32 v36, 0
    v_mov_b32 v37, 0
    v_mov_b32 v38, 0
    v_mov_b32 v39, 0
    v_mov_b32 v40, 161024
    ds_write_b128 v40, v[36:39]
L_fz_1:
    s_waitcnt lgkmcnt(0)
    s_barrier
    s_mov_b32 s8, s86
    s_mov_b32 s9, s87
    s_mov_b32 s10, 0x400000
    s_mov_b32 s11, 0x20000
    s_mov_b32 s54, 0x3f0000
    s_load_dword s63, s[8:9], s54
    s_add_u32 s28, s64, s62
    s_addc_u32 s29, s65, 0
    s_sub_u32 s30, 1280, s62
    s_mov_b32 s31, 0x20000
    s_cmp_lg_u32 s6, 7
    s_cbranch_scc1 L_p7_2
    v_mov_b32 v36, -1
    v_mov_b32 v37, -1
    v_mov_b32 v38, -1
    v_mov_b32 v39, -1
    v_lshlrev_b32 v28, 4, v1
    v_add_u32 v28, s44, v28
    s_mov_b32 s56, 3328
    buffer_store_dwordx4 v[36:39], v28, s[8:11], s56 offen sc1
    s_mov_b32 s56, 4352
    buffer_store_dwordx4 v[36:39], v28, s[8:11], s56 offen sc1
    s_mov_b32 s56, 5376
    buffer_store_dwordx4 v[36:39], v28, s[8:11], s56 offen sc1
    s_mov_b32 s56, 6400
    buffer_store_dwordx4 v[36:39], v28, s[8:11], s56 offen sc1
    s_mul_i32 s56, s5, 10240
    s_lshl_b32 s57, s4, 6
    s_add_u32 s56, s56, s57
    s_add_u32 s56, s56, 0x200000
    v_lshrrev_b32 v30, 2, v1
    v_mul_u32_u24 v31, 52, v30
    v_lshrrev_b32 v31, 8, v31
    v_mul_u32_u24 v32, 5, v31
    v_sub_u32_e64 v32, v30, v32
    v_mul_u32_u24 v31, 81920, v31
    v_lshl_add_u32 v31, v32, 11, v31
    v_and_b32_e64 v32, 3, v1
    v_lshl_add_u32 v31, v32, 4, v31
    v_add_u32_e64 v31, s56, v31
    buffer_store_dwordx4 v[36:39], v31, s[8:11], 0 offen sc1
    v_lshrrev_b32 v30, 2, v1
    v_add_u32 v30, 16, v30
    v_min_u32 v30, 19, v30
    v_mul_u32_u24 v31, 52, v30
    v_lshrrev_b32 v31, 8, v31
    v_mul_u32_u24 v32, 5, v31
    v_sub_u32_e64 v32, v30, v32
    v_mul_u32_u24 v31, 81920, v31
    v_lshl_add_u32 v31, v32, 11, v31
    v_and_b32_e64 v32, 3, v1
    v_lshl_add_u32 v31, v32, 4, v31
    v_add_u32_e64 v31, s56, v31
    buffer_store_dwordx4 v[36:39], v31, s[8:11], 0 offen sc1
    v_mov_b32 v60, 0
    v_lshlrev_b32_e64 v61, 2, v1
    s_mov_b32 s54, -1
    s_mov_b32 s55, 0xff
    s_mov_b64 exec, s[54:55]
    buffer_load_dword v60, v61, s[28:31], 0 offen
    s_mov_b64 exec, -1
L_p7_2:
    s_add_u32 s24, s70, s61
    s_addc_u32 s25, s71, 0
    s_sub_u32 s26, 7864320, s61
    s_mov_b32 s27, 0x20000
    s_add_u32 s16, s66, s60
    s_addc_u32 s17, s67, 0
    s_sub_u32 s18, 100663296, s60
    s_mov_b32 s19, 0x20000
    s_cmp_ge_u32 s6, 4
    s_cbranch_scc1 L_wqe_3
    s_add_u32 s56, s6, 0
    s_mul_i32 s57, s56, 98304
    s_mul_i32 s56, s56, 3072
    s_add_u32 m0, s56, 0
    s_nop 0
    buffer_load_dwordx4 v24, s[24:27], s57 offen nt lds
    s_add_u32 m0, s56, 1024
    s_nop 0
    buffer_load_dwordx4 v25, s[24:27], s57 offen nt lds
    s_add_u32 m0, s56, 2048
    s_nop 0
    buffer_load_dwordx4 v26, s[24:27], s57 offen nt lds
    s_add_u32 s56, s6, 4
    s_mul_i32 s57, s56, 98304
    s_mul_i32 s56, s56, 3072
    s_add_u32 m0, s56, 0
    s_nop 0
    buffer_load_dwordx4 v24, s[24:27], s57 offen nt lds
    s_add_u32 m0, s56, 1024
    s_nop 0
    buffer_load_dwordx4 v25, s[24:27], s57 offen nt lds
    s_add_u32 m0, s56, 2048
    s_nop 0
    buffer_load_dwordx4 v26, s[24:27], s57 offen nt lds
    s_cmp_ge_u32 s6, 2
    s_cbranch_scc1 L_wqe_3
    s_add_u32 s56, s6, 8
    s_mul_i32 s57, s56, 98304
    s_mul_i32 s56, s56, 3072
    s_add_u32 m0, s56, 0
    s_nop 0
    buffer_load_dwordx4 v24, s[24:27], s57 offen nt lds
    s_add_u32 m0, s56, 1024
    s_nop 0
    buffer_load_dwordx4 v25, s[24:27], s57 offen nt lds
    s_add_u32 m0, s56, 2048
    s_nop 0
    buffer_load_dwordx4 v26, s[24:27], s57 offen nt lds
L_wqe_3:
    s_cmp_ge_u32 s6, 4
    s_cbranch_scc1 L_xf_4
    v_lshlrev_b32 v32, 3, v2
    buffer_load_dwordx2 v[96:97], v32, s[28:31], 0 offen offset:0
    buffer_load_dwordx2 v[98:99], v32, s[28:31], 0 offen offset:32
    buffer_load_dwordx2 v[100:101], v32, s[28:31], 0 offen offset:64
    buffer_load_dwordx2 v[102:103], v32, s[28:31], 0 offen offset:96
    buffer_load_dwordx2 v[104:105], v32, s[28:31], 0 offen offset:128
L_xf_4:
    s_mul_i32 s57, s6, 12288
    s_add_u32 s56, s57, 30720
    s_add_u32 s58, s57, 3072
    s_add_u32 m0, s56, 0
    s_nop 0
    buffer_load_dwordx4 v74, s[16:19], s57 offen nt lds
    s_add_u32 m0, s56, 1024
    s_nop 0
    buffer_load_dwordx4 v75, s[16:19], s57 offen nt lds
    s_add_u32 m0, s56, 2048
    s_nop 0
    buffer_load_dwordx4 v76, s[16:19], s57 offen nt lds
    s_add_u32 m0, s56, 3072
    s_nop 0
    buffer_load_dwordx4 v74, s[16:19], s58 offen nt lds
    s_add_u32 m0, s56, 4096
    s_nop 0
    buffer_load_dwordx4 v75, s[16:19], s58 offen nt lds
    s_add_u32 m0, s56, 5120
    s_nop 0
    buffer_load_dwordx4 v76, s[16:19], s58 offen nt lds
    s_add_u32 s20, s68, s60
    s_addc_u32 s21, s69, 0
    s_sub_u32 s22, 100663296, s60
    s_mov_b32 s23, 0x20000
    s_mov_b32 s12, s84
    s_mov_b32 s13, s85
    s_mov_b32 s14, 256
    s_mov_b32 s15, 0x20000
    s_mov_b32 s47, 0
    s_mov_b32 s46, 0
    s_mov_b32 s7, 0
    s_mul_i32 s49, s7, 3328
    s_lshl_b32 s50, s7, 9
    s_add_u32 s50, s50, 4224
    s_lshl_b32 s51, s7, 10
    s_add_u32 s51, s51, 5248
    s_mul_i32 s52, s7, 163840
    s_add_u32 s53, s52, 81920
    s_min_u32 s55, s6, 4
    v_bfe_u32 v30, v1, 2, 2
    v_lshlrev_b32 v31, 1, v30
    v_lshrrev_b32 v32, 1, v30
    v_and_b32 v31, 2, v31
    v_or_b32_e64 v31, v31, v32
    v_lshl_add_u32 v31, v2, 2, v31
    s_lshl_b32 s56, s55, 4
    v_add_u32 v31, s56, v31
    v_lshlrev_b32 v50, 1, v31
    v_mov_b32 v11, v50
    v_and_b32 v5, 0x63, v31
    v_bfe_u32 v32, v31, 2, 2
    v_lshl_add_u32 v5, v32, 3, v5
    v_bfe_u32 v32, v31, 4, 1
    v_lshl_add_u32 v5, v32, 2, v5
    v_lshlrev_b32_e64 v5, 1, v5
    v_add_u32 v5, 159744, v5
    buffer_load_ushort v13, v50, s[28:31], 0 offen
    s_mov_b32 s32, 0x10001
    s_mov_b32 s33, 0x10001
    s_mov_b32 s34, 0x30003
    s_mov_b32 s35, 0x30003
    s_mov_b32 s36, 0x11111111
    s_mov_b32 s37, 0x11111111
    s_mov_b32 s38, 0x110011
    s_mov_b32 s39, 0x110011
    s_mov_b32 s42, 0x0
    s_mov_b32 s43, 0x80000000
    s_cmp_eq_u32 s7, 0
    s_cselect_b64 s[40:41], s[34:35], s[32:33]
    v_mov_b32 v108, s44
    v_mov_b32 v80, 0
    v_mov_b32 v81, 0
    v_mov_b32 v82, 0
    v_mov_b32 v83, 0
    v_mov_b32 v84, 0
    v_mov_b32 v85, 0
    v_mov_b32 v86, 0
    v_mov_b32 v87, 0
    v_bfe_u32 v44, v3, 2, 1
    v_mov_b32 v88, 0x44444444
    v_mov_b32 v45, 0xeeeeeeee
    v_cmp_eq_u32 vcc, 1, v44
    s_nop 1
    v_cndmask_b32 v88, v88, v45, vcc
    v_lshlrev_b32 v44, 4, v2
    v_add_u32 v4, 159744, v44
    v_add_u32 v70, 160512, v44
    v_add_u32 v45, 159936, v44
    v_cmp_eq_u32 vcc, 1, v3
    s_nop 1
    v_cndmask_b32_e64 v4, v4, v45, vcc
    s_mul_i32 s54, s6, 192
    s_add_u32 s54, s54, s44
    v_lshlrev_b32 v44, 4, v2
    v_mul_u32_u24 v45, 768, v3
    v_add3_u32 v17, v44, v45, s54
    s_lshl_b32 s54, s6, 6
    s_add_u32 s54, s54, s44
    v_mul_u32_u24 v45, 384, v3
    v_add3_u32 v18, v44, v45, s54
    v_bfe_u32 v45, v3, 1, 1
    v_mov_b32 v95, 0x44444444
    v_mov_b32 v46, 0xeeeeeeee
    v_cmp_eq_u32 vcc, 1, v45
    s_nop 1
    v_cndmask_b32_e64 v95, v95, v46, vcc
    v_mul_u32_u24 v19, 192, v45
    v_and_b32_e64 v45, 1, v3
    v_lshl_add_u32 v19, v45, 5, v19
    v_and_b32_e64 v45, 1, v2
    v_lshl_add_u32 v19, v45, 4, v19
    v_add_u32 v19, 160128, v19
    v_lshrrev_b32 v45, 1, v2
    v_lshrrev_b32_e64 v46, 2, v3
    v_mul_i32_i24 v47, 64, v45
    v_add3_u32 v89, v47, v19, 0
    v_mov_b32 v47, 0
    v_cmp_eq_u32 vcc, v47, v46
    v_mov_b32 v48, 160768
    s_nop 0
    v_cndmask_b32 v89, v48, v89, vcc
    v_mul_i32_i24 v47, -128, v45
    v_add_u32 v47, 128, v47
    v_add_u32 v90, v47, v19
    v_add_u32 v47, 0, v45
    v_cmp_eq_u32_e64 vcc, v47, v46
    v_mov_b32 v48, 160768
    s_nop 0
    v_cndmask_b32_e64 v90, v48, v90, vcc
    v_mul_i32_i24 v47, 64, v45
    v_add3_u32 v91, v47, v19, 64
    v_mov_b32 v47, 1
    v_cmp_eq_u32 vcc, v47, v46
    v_mov_b32 v48, 160768
    s_nop 0
    v_cndmask_b32_e64 v91, v48, v91, vcc
    v_mul_i32_i24 v47, 64, v45
    v_add3_u32 v92, v47, v19, 0
    v_mov_b32 v47, 2
    v_cmp_eq_u32 vcc, v47, v46
    v_mov_b32 v48, 160768
    s_nop 0
    v_cndmask_b32 v92, v48, v92, vcc
    v_mul_i32_i24 v47, -128, v45
    v_add_u32 v47, 128, v47
    v_add_u32 v93, v47, v19
    v_add_u32 v47, 2, v45
    v_cmp_eq_u32_e64 vcc, v47, v46
    v_mov_b32 v48, 160768
    s_nop 0
    v_cndmask_b32_e64 v93, v48, v93, vcc
    v_mul_i32_i24 v47, 64, v45
    v_add3_u32 v94, v47, v19, 64
    v_mov_b32 v47, 3
    v_cmp_eq_u32 vcc, v47, v46
    v_mov_b32 v48, 160768
    s_nop 0
    v_cndmask_b32 v94, v48, v94, vcc
    s_mul_i32 s54, s6, 12288
    s_add_u32 s54, s54, 30720
    v_lshlrev_b32 v44, 2, v1
    v_add_u32_e64 v71, s54, v44
    s_lshl_b32 s54, s6, 8
    s_add_u32 s54, s54, 30720
    v_add_u32_e64 v77, s54, v44
    v_add_u32 v78, 61440, v77
    s_lshl_b32 s54, s6, 2
    s_add_u32 s54, s54, 160640
    v_mov_b32_e64 v73, s54
    s_min_u32 s55, s6, 4
    s_mul_i32 s54, s5, 10240
    s_lshl_b32 s56, s55, 11
    s_add_u32 s54, s54, s56
    s_add_u32 s54, s54, 0x200000
    v_lshlrev_b32_e64 v44, 6, v3
    v_lshl_add_u32 v44, v2, 4, v44
    v_add_u32 v6, s54, v44
    s_lshl_b32 s56, s4, 6
    s_add_u32 s54, s54, s56
    v_lshlrev_b32 v44, 4, v2
    v_add_u32 v8, s54, v44
    v_lshrrev_b32 v45, 2, v3
    v_lshl_add_u32 v7, v45, 3, v8
    s_lshl_b32 s54, s6, 8
    s_add_u32 s54, s54, s45
    v_lshlrev_b32_e64 v44, 13, v2
    v_lshl_add_u32 v44, v3, 4, v44
    v_add_u32 v9, s54, v44
    v_and_b32 v44, 7, v1
    v_lshlrev_b32 v44, 13, v44
    v_add_u32 v10, s45, v44
    v_lshrrev_b32 v44, 3, v1
    v_lshlrev_b32 v45, 13, v44
    v_add_u32 v156, s45, v45
    s_sub_u32 s54, s6, 5
    s_lshl_b32 s54, s54, 3
    v_and_b32 v46, 7, v1
    v_add_u32_e64 v46, s54, v46
    v_lshl_add_u32 v0, v46, 4, v156
    v_mul_u32_u24 v45, 400, v44
    v_lshl_add_u32 v45, v46, 4, v45
    v_add_u32 v157, 31744, v45
    v_and_b32_e64 v44, 7, v3
    v_mul_u32_u24 v45, 400, v44
    v_lshl_add_u32 v45, v2, 4, v45
    v_add_u32 v158, 31744, v45
    v_lshlrev_b32_e64 v44, 3, v44
    v_add_u32 v159, 34944, v44
    s_sub_u32 s54, s6, 6
    s_lshl_b32 s54, s54, 3
    v_and_b32 v44, 7, v1
    v_add_u32 v44, s54, v44
    v_min_u32 v44, 11, v44
    v_lshrrev_b32 v45, 3, v1
    v_lshlrev_b32_e64 v45, 13, v45
    v_lshl_add_u32 v45, v44, 4, v45
    v_add_u32 v12, s45, v45
    v_lshlrev_b32 v46, 1, v2
    v_lshrrev_b32 v47, 1, v2
    v_and_b32 v46, 2, v46
    v_or_b32_e64 v46, v46, v47
    v_lshl_add_u32 v44, v44, 2, v46
    v_and_b32 v69, 0x63, v44
    v_bfe_u32 v47, v44, 2, 2
    v_lshl_add_u32 v69, v47, 3, v69
    v_bfe_u32 v47, v44, 4, 1
    v_lshl_add_u32 v69, v47, 2, v69
    v_lshlrev_b32_e64 v69, 1, v69
    v_add_u32 v69, 160512, v69
    s_lshl_b32 s54, s6, 6
    s_add_u32 s54, s54, 160128
    v_lshl_add_u32 v68, v3, 2, s54
    v_bfe_u32 v44, v46, 1, 1
    v_mul_u32_u24 v44, 192, v44
    v_add_u32 v68, v68, v44
    v_and_b32_e64 v44, 1, v46
    v_lshl_add_u32 v68, v44, 1, v68
    v_lshrrev_b32 v44, 5, v1
    v_lshlrev_b32 v44, 6, v44
    v_bfe_u32 v45, v1, 2, 2
    v_lshl_add_u32 v44, v45, 4, v44
    v_bfe_u32 v45, v1, 4, 1
    v_lshl_add_u32 v44, v45, 3, v44
    s_lshl_b32 s54, s6, 7
    s_add_u32 s54, s54, s44
    v_add_u32 v72, s54, v44
    v_and_b32 v44, 7, v1
    v_lshlrev_b32_e64 v44, 2, v44
    v_add_u32 v19, 160640, v44
    s_cmp_lg_u32 s6, 0
    s_cbranch_scc1 L_c0_6
    v_lshlrev_b32_e64 v44, 2, v1
    v_add_u32 v44, 159936, v44
    v_mov_b32 v45, 0x3f803f80
    s_mov_b32 s54, -1
    s_mov_b32 s55, 0xffff
    s_mov_b64 exec, s[54:55]
    ds_write_b32 v44, v45
    v_mov_b32_e64 v45, 0
    ds_write_b32 v44, v45 offset:576
    ds_write_b32 v44, v45 offset:832
    v_subrev_u32 v44, 192, v44
    ds_write_b32 v44, v45
    s_mov_b64 exec, -1
L_c0_6:
    v_lshrrev_b32 v65, 2, v3
    v_lshl_add_u32 v65, v2, 2, v65
    v_mul_u32_u24 v64, 384, v65
    v_and_b32_e64 v65, 6, v65
    v_bfe_u32 v66, v3, 1, 1
    v_xor_b32_e64 v65, v65, v66
    v_lshl_add_u32 v64, v65, 4, v64
    v_and_b32_e64 v66, 1, v3
    v_lshl_add_u32 v64, v66, 3, v64
    s_waitcnt lgkmcnt(0)
    s_add_u32 s63, s63, 1
    s_cmp_lg_u32 s6, 4
    s_cbranch_scc1 L_ld_7
    s_setprio 3
    s_sub_u32 s59, s6, 4
    s_mul_i32 s59, s59, 98304
    s_add_u32 s56, s59, 36864
    s_add_u32 s57, s59, 6144
    s_add_u32 s58, s59, 9216
    s_mov_b32 s59, 0
.p2align 6
L_kv_8:
    s_add_u32 m0, s56, 0
    s_nop 0
    buffer_load_dwordx4 v74, s[16:19], s57 offen nt lds
    s_add_u32 m0, s56, 1024
    s_nop 0
    buffer_load_dwordx4 v75, s[16:19], s57 offen nt lds
    s_add_u32 m0, s56, 2048
    s_nop 0
    buffer_load_dwordx4 v76, s[16:19], s57 offen nt lds
    s_add_u32 m0, s56, 3072
    s_nop 0
    buffer_load_dwordx4 v74, s[16:19], s58 offen nt lds
    s_add_u32 m0, s56, 4096
    s_nop 0
    buffer_load_dwordx4 v75, s[16:19], s58 offen nt lds
    s_add_u32 m0, s56, 5120
    s_nop 0
    buffer_load_dwordx4 v76, s[16:19], s58 offen nt lds
    s_add_u32 s56, s56, 12288
    s_add_u32 s57, s57, 12288
    s_add_u32 s58, s58, 12288
    s_add_u32 s59, s59, 1
    s_cmp_lt_u32 s59, 8
    s_cbranch_scc1 L_kv_8
L_ld_7:
    s_cmp_ge_u32 s6, 4
    s_cbranch_scc1 L_l1w_9
    s_lshl_b32 s54, s6, 2
    s_add_u32 s54, s54, 161024
    v_mov_b32 v32, s54
    v_mov_b32_e64 v33, 1
    v_mov_b32 v34, 161024
    s_waitcnt vmcnt(7)
    ds_write_b32 v32, v33
L_wqs_10:
    ds_read_b128 v[36:39], v34
    s_waitcnt lgkmcnt(0)
    v_and_b32 v36, v36, v37
    v_and_b32 v38, v38, v39
    v_and_b32 v36, v36, v38
    s_nop 0
    v_readfirstlane_b32 s54, v36
    s_cmp_eq_u32 s54, 1
    s_cbranch_scc1 L_wqg_11
    s_add_u32 s47, s47, 1
    s_cmp_lt_u32 s47, 0x40000
    s_cbranch_scc1 L_wqs_10
    s_branch L_end
L_wqg_11:
L_l1w_9:
    s_cmp_lg_u32 s6, 7
    s_cbranch_scc1 L_l17s_12
    s_waitcnt vmcnt(7)
    s_and_b32 s56, s2, 7
    s_lshl_b32 s56, s56, 5
    v_mov_b32 v30, s56
    v_mov_b32 v31, 1
    s_mov_b64 exec, 1
    buffer_atomic_add v31, v30, s[12:15], 0 offen
    s_mov_b64 exec, -1
    v_lshlrev_b32 v62, 16, v60
    v_and_b32 v63, 0xffff0000, v60
    v_add_f32 v60, v62, v63
    v_mul_f32 v61, v62, v62
    v_fmac_f32_e64 v61, v63, v63
    v_add_f32_dpp v60, v60, v60 quad_perm:[1,0,3,2] row_mask:0xf bank_mask:0xf
    s_nop 0
    v_add_f32_dpp v61, v61, v61 quad_perm:[1,0,3,2] row_mask:0xf bank_mask:0xf
    v_add_f32_dpp v60, v60, v60 quad_perm:[2,3,0,1] row_mask:0xf bank_mask:0xf
    s_nop 0
    v_add_f32_dpp v61, v61, v61 quad_perm:[2,3,0,1] row_mask:0xf bank_mask:0xf
    v_add_f32_dpp v60, v60, v60 row_half_mirror row_mask:0xf bank_mask:0xf
    s_nop 0
    v_add_f32_dpp v61, v61, v61 row_half_mirror row_mask:0xf bank_mask:0xf
    v_add_f32_dpp v60, v60, v60 row_mirror row_mask:0xf bank_mask:0xf
    s_nop 0
    v_add_f32_dpp v61, v61, v61 row_mirror row_mask:0xf bank_mask:0xf
    v_add_f32_dpp v60, v60, v60 row_bcast:15 row_mask:0xa bank_mask:0xf
    s_nop 0
    v_add_f32_dpp v61, v61, v61 row_bcast:15 row_mask:0xa bank_mask:0xf
    v_add_f32_dpp v60, v60, v60 row_bcast:31 row_mask:0xc bank_mask:0xf
    s_nop 0
    v_add_f32_dpp v61, v61, v61 row_bcast:31 row_mask:0xc bank_mask:0xf
    s_getreg_b32 s57, hwreg(HW_REG_XCC_ID, 0, 4)
    v_mov_b32 v24, v60
    v_mov_b32 v25, s63
    v_mov_b32 v26, v61
    v_mov_b32 v27, s63
    v_mov_b32 v28, s57
    v_mov_b32 v29, s63
    v_mov_b32_e64 v30, s44
    s_mov_b64 exec, s[42:43]
    buffer_store_dwordx4 v[24:27], v30, s[8:11], 0 offen offset:3072 sc1
    buffer_store_dwordx2 v[28:29], v30, s[8:11], 0 offen offset:3088 sc1
    s_mov_b64 exec, -1
L_l17s_12:
    s_cmp_ge_u32 s6, 4
    s_cbranch_scc1 L_l1q_13
    s_mul_i32 s54, s6, 3
    s_add_u32 s54, s54, 0
    s_and_b32 s55, s54, 3
    s_lshl_b32 s55, s55, 5
    s_lshr_b32 s56, s54, 2
    s_lshl_b32 s56, s56, 7
    v_xor_b32 v67, s55, v64
    v_add_u32_e64 v67, s56, v67
    ds_read_b64_tr_b16 v[120:121], v67 offset:0
    ds_read_b64_tr_b16 v[122:123], v67 offset:6144
    ds_read_b64_tr_b16 v[124:125], v67 offset:12288
    ds_read_b64_tr_b16 v[126:127], v67 offset:18432
    ds_read_b64_tr_b16 v[128:129], v67 offset:24576
    v_mov_b32 v130, 0
    v_mov_b32 v131, 0
    s_mul_i32 s54, s6, 3
    s_add_u32 s54, s54, 1
    s_and_b32 s55, s54, 3
    s_lshl_b32 s55, s55, 5
    s_lshr_b32 s56, s54, 2
    s_lshl_b32 s56, s56, 7
    v_xor_b32 v67, s55, v64
    v_add_u32 v67, s56, v67
    ds_read_b64_tr_b16 v[132:133], v67 offset:0
    ds_read_b64_tr_b16 v[134:135], v67 offset:6144
    ds_read_b64_tr_b16 v[136:137], v67 offset:12288
    ds_read_b64_tr_b16 v[138:139], v67 offset:18432
    ds_read_b64_tr_b16 v[140:141], v67 offset:24576
    v_mov_b32 v142, 0
    v_mov_b32 v143, 0
    s_mul_i32 s54, s6, 3
    s_add_u32 s54, s54, 2
    s_and_b32 s55, s54, 3
    s_lshl_b32 s55, s55, 5
    s_lshr_b32 s56, s54, 2
    s_lshl_b32 s56, s56, 7
    v_xor_b32 v67, s55, v64
    v_add_u32 v67, s56, v67
    ds_read_b64_tr_b16 v[144:145], v67 offset:0
    ds_read_b64_tr_b16 v[146:147], v67 offset:6144
    ds_read_b64_tr_b16 v[148:149], v67 offset:12288
    ds_read_b64_tr_b16 v[150:151], v67 offset:18432
    ds_read_b64_tr_b16 v[152:153], v67 offset:24576
    v_mov_b32 v154, 0
    v_mov_b32 v155, 0
    v_mov_b32 v20, v96
    v_mov_b32 v21, v97
    v_mov_b32 v22, v98
    v_mov_b32 v23, v99
    v_mov_b32 v24, v100
    v_mov_b32 v25, v101
    v_mov_b32 v26, v102
    v_mov_b32 v27, v103
    v_mov_b32 v28, v104
    v_mov_b32 v29, v105
    s_mov_b32 s54, 0x20002
    s_mov_b32 s55, 0x20002
    s_mov_b64 exec, s[54:55]
    v_mov_b32 v20, 0x3f803f80
    v_mov_b32 v21, 0x3f803f80
    v_mov_b32 v22, 0x3f803f80
    v_mov_b32 v23, 0x3f803f80
    v_mov_b32 v24, 0x3f803f80
    v_mov_b32 v25, 0x3f803f80
    v_mov_b32 v26, 0x3f803f80
    v_mov_b32 v27, 0x3f803f80
    v_mov_b32 v28, 0x3f803f80
    v_mov_b32 v29, 0x3f803f80
    s_mov_b64 exec, -1
    v_mov_b32 v30, 0
    v_mov_b32_e64 v31, 0
    s_waitcnt lgkmcnt(0)
    v_mfma_f32_16x16x32_bf16 v[36:39], v[120:123], v[20:23], 0
    v_mfma_f32_16x16x32_bf16 v[36:39], v[124:127], v[24:27], v[36:39]
    v_mfma_f32_16x16x32_bf16 v[36:39], v[128:131], v[28:31], v[36:39]
    v_mfma_f32_16x16x32_bf16 v[40:43], v[132:135], v[20:23], 0
    v_mfma_f32_16x16x32_bf16 v[40:43], v[136:139], v[24:27], v[40:43]
    v_mfma_f32_16x16x32_bf16 v[40:43], v[140:143], v[28:31], v[40:43]
    v_mfma_f32_16x16x32_bf16 v[44:47], v[144:147], v[20:23], 0
    v_mfma_f32_16x16x32_bf16 v[44:47], v[148:151], v[24:27], v[44:47]
    v_mfma_f32_16x16x32_bf16 v[44:47], v[152:155], v[28:31], v[44:47]
    s_nop 0
    s_nop 6
    s_mul_i32 s54, s6, 384
    s_add_u32 s54, s54, s44
    v_lshlrev_b32 v56, 5, v2
    v_mul_u32_u24 v57, 1536, v3
    v_add3_u32 v56, v56, v57, s54
    v_mov_b32 v49, s63
    v_mov_b32 v51, s63
    v_mov_b32 v53, s63
    v_mov_b32 v55, s63
    v_mov_b32 v108, v56
    v_mov_b32 v96, v36
    v_mov_b32 v97, v37
    v_mov_b32 v98, v38
    v_mov_b32 v99, v39
    v_mov_b32 v100, v40
    v_mov_b32 v101, v41
    v_mov_b32 v102, v42
    v_mov_b32 v103, v43
    v_mov_b32 v104, v44
    v_mov_b32 v105, v45
    v_mov_b32 v106, v46
    v_mov_b32 v107, v47
    v_mov_b32 v48, v36
    v_mov_b32 v50, v37
    v_mov_b32 v52, v38
    v_mov_b32 v54, v39
    s_mov_b64 exec, s[34:35]
    buffer_store_dwordx4 v[48:51], v56, s[8:11], 0 offen offset:0
    buffer_store_dwordx4 v[52:55], v56, s[8:11], 0 offen offset:16
    s_mov_b64 exec, -1
    v_mov_b32 v48, v40
    v_mov_b32 v50, v41
    v_mov_b32 v52, v42
    v_mov_b32 v54, v43
    s_mov_b64 exec, s[34:35]
    buffer_store_dwordx4 v[48:51], v56, s[8:11], 0 offen offset:128
    buffer_store_dwordx4 v[52:55], v56, s[8:11], 0 offen offset:144
    s_mov_b64 exec, -1
    v_mov_b32 v48, v44
    v_mov_b32 v50, v45
    v_mov_b32 v52, v46
    v_mov_b32 v54, v47
    s_mov_b64 exec, s[34:35]
    buffer_store_dwordx4 v[48:51], v56, s[8:11], 0 offen offset:256
    buffer_store_dwordx4 v[52:55], v56, s[8:11], 0 offen offset:272
    s_mov_b64 exec, -1
L_l1q_13:
    v_and_b32 v62, 7, v3
    v_mul_u32_u24 v60, 384, v62
    v_lshrrev_b32_e64 v63, 3, v3
    v_lshl_add_u32 v63, v63, 2, v2
    v_and_b32 v62, 6, v62
    v_xor_b32 v63, v63, v62
    v_lshl_add_u32 v60, v63, 4, v60
    s_mul_i32 s56, s6, 12288
    s_add_u32 s56, s56, 30720
    v_add_u32 v60, s56, v60
    s_cmp_eq_u32 s6, 5
    s_cbranch_scc1 L_wbh_16
    s_cmp_eq_u32 s6, 6
    s_cbranch_scc1 L_wbh_16
    s_branch L_wbn_15
L_wbh_16:
    s_waitcnt vmcnt(1)
    s_branch L_wbw_14
L_wbn_15:
    s_cmp_eq_u32 s6, 7
    s_cbranch_scc1 L_wbh_18
    s_branch L_wbn_17
L_wbh_18:
    s_waitcnt vmcnt(4)
    s_branch L_wbw_14
L_wbn_17:
    s_cmp_eq_u32 s6, 0
    s_cbranch_scc1 L_wbh_20
    s_cmp_eq_u32 s6, 1
    s_cbranch_scc1 L_wbh_20
    s_cmp_eq_u32 s6, 2
    s_cbranch_scc1 L_wbh_20
    s_cmp_eq_u32 s6, 3
    s_cbranch_scc1 L_wbh_20
    s_branch L_wbn_19
L_wbh_20:
    s_waitcnt vmcnt(7)
    s_branch L_wbw_14
L_wbn_19:
    s_waitcnt vmcnt(49)
L_wbw_14:
    ds_read_b128 v[208:211], v60 offset:0
    ds_read_b128 v[212:215], v60 offset:128
    ds_read_b128 v[216:219], v60 offset:256
    ds_read_b128 v[220:223], v60 offset:3072
    ds_read_b128 v[224:227], v60 offset:3200
    ds_read_b128 v[228:231], v60 offset:3328
    s_waitcnt lgkmcnt(0)
    s_barrier
    s_cmp_lg_u32 s6, 4
    s_cbranch_scc1 L_ld_21
    s_sub_u32 s59, s6, 4
    s_mul_i32 s59, s59, 98304
    s_add_u32 s56, s59, 30720
    s_add_u32 s57, s59, 0
    s_add_u32 s58, s59, 3072
    s_mov_b32 s59, 0
.p2align 6
L_kv_22:
    s_add_u32 m0, s56, 0
    s_nop 0
    buffer_load_dwordx4 v74, s[20:23], s57 offen nt lds
    s_add_u32 m0, s56, 1024
    s_nop 0
    buffer_load_dwordx4 v75, s[20:23], s57 offen nt lds
    s_add_u32 m0, s56, 2048
    s_nop 0
    buffer_load_dwordx4 v76, s[20:23], s57 offen nt lds
    s_add_u32 m0, s56, 3072
    s_nop 0
    buffer_load_dwordx4 v74, s[20:23], s58 offen nt lds
    s_add_u32 m0, s56, 4096
    s_nop 0
    buffer_load_dwordx4 v75, s[20:23], s58 offen nt lds
    s_add_u32 m0, s56, 5120
    s_nop 0
    buffer_load_dwordx4 v76, s[20:23], s58 offen nt lds
    s_add_u32 s56, s56, 12288
    s_add_u32 s57, s57, 12288
    s_add_u32 s58, s58, 12288
    s_add_u32 s59, s59, 1
    s_cmp_lt_u32 s59, 8
    s_cbranch_scc1 L_kv_22
    s_waitcnt vmcnt(48)
L_ld_21:
    s_cmp_ge_u32 s6, 3
    s_cbranch_scc1 L_qg0s_23
    s_lshl_b32 s54, s6, 9
    s_add_u32 s54, s54, s45
    v_lshlrev_b32 v56, 13, v2
    v_lshl_add_u32 v56, v3, 5, v56
    v_add_u32_e64 v56, s54, v56
    s_mov_b32 s55, 32768
    buffer_load_dwordx4 v[20:23], v56, s[8:11], 0 offen offset:0 sc1
    buffer_load_dwordx4 v[36:39], v56, s[8:11], 0 offen offset:1536 sc1
    buffer_load_dwordx4 v[24:27], v56, s[8:11], 0 offen offset:16 sc1
    buffer_load_dwordx4 v[40:43], v56, s[8:11], 0 offen offset:1552 sc1
    buffer_load_dwordx4 v[28:31], v56, s[8:11], s55 offen offset:0 sc1
    buffer_load_dwordx4 v[44:47], v56, s[8:11], s55 offen offset:1536 sc1
    buffer_load_dwordx4 v[32:35], v56, s[8:11], s55 offen offset:16 sc1
    buffer_load_dwordx4 v[48:51], v56, s[8:11], s55 offen offset:1552 sc1
    buffer_load_dwordx4 v[52:55], v10, s[8:11], 0 offen offset:3072 sc1
    buffer_load_dwordx2 v[58:59], v10, s[8:11], 0 offen offset:3088 sc1
L_qg0s_23:
    s_cmp_lg_u32 s6, 3
    s_cbranch_scc1 L_qg0h_24
    buffer_load_dwordx2 v[58:59], v10, s[8:11], 0 offen offset:3088 sc1
L_qg0h_24:
    s_mov_b32 s3, 0
    s_barrier
    v_lshlrev_b32_e64 v13, 16, v13
    ds_read_b128 v[232:235], v60 offset:6144
    ds_read_b128 v[236:239], v60 offset:6272
    ds_read_b128 v[240:243], v60 offset:6400
    ds_read_b128 v[244:247], v60 offset:9216
    ds_read_b128 v[248:251], v60 offset:9344
    ds_read_b128 v[252:255], v60 offset:9472
    s_waitcnt lgkmcnt(0)
    s_cmp_lg_u32 s6, 7
    s_cbranch_scc1 L_hsi_25
    v_and_b32 v97, 7, v1
    v_lshlrev_b32_e64 v97, 5, v97
    buffer_load_dword v96, v97, s[12:15], 0 offen sc1
L_hsi_25:
    s_barrier
    s_cmp_lg_u32 s6, 4
    s_cbranch_scc1 L_ld_26
    s_sub_u32 s59, s6, 4
    s_mul_i32 s59, s59, 98304
    s_add_u32 s56, s59, 36864
    s_add_u32 s57, s59, 6144
    s_add_u32 s58, s59, 9216
    s_mov_b32 s59, 0
.p2align 6
L_kv_27:
    s_add_u32 m0, s56, 0
    s_nop 0
    buffer_load_dwordx4 v74, s[20:23], s57 offen nt lds
    s_add_u32 m0, s56, 1024
    s_nop 0
    buffer_load_dwordx4 v75, s[20:23], s57 offen nt lds
    s_add_u32 m0, s56, 2048
    s_nop 0
    buffer_load_dwordx4 v76, s[20:23], s57 offen nt lds
    s_add_u32 m0, s56, 3072
    s_nop 0
    buffer_load_dwordx4 v74, s[20:23], s58 offen nt lds
    s_add_u32 m0, s56, 4096
    s_nop 0
    buffer_load_dwordx4 v75, s[20:23], s58 offen nt lds
    s_add_u32 m0, s56, 5120
    s_nop 0
    buffer_load_dwordx4 v76, s[20:23], s58 offen nt lds
    s_add_u32 s56, s56, 12288
    s_add_u32 s57, s57, 12288
    s_add_u32 s58, s58, 12288
    s_add_u32 s59, s59, 1
    s_cmp_lt_u32 s59, 8
    s_cbranch_scc1 L_kv_27
    s_waitcnt vmcnt(48)
L_ld_26:
    s_barrier
    s_cmp_lg_u32 s6, 6
    s_cbranch_scc1 L_warm_28
    v_lshlrev_b32 v28, 4, v1
    v_add_u32 v28, s44, v28
    s_mov_b32 s56, 3328
    buffer_load_dwordx4 v[96:99], v28, s[8:11], s56 offen sc1
    s_mov_b32 s56, 4352
    buffer_load_dwordx4 v[100:103], v28, s[8:11], s56 offen sc1
    s_mov_b32 s56, 5376
    buffer_load_dwordx4 v[104:107], v28, s[8:11], s56 offen sc1
    s_mov_b32 s56, 6400
    buffer_load_dwordx4 v[108:111], v28, s[8:11], s56 offen sc1
L_warm_28:
    v_bfe_u32 v65, v3, 2, 1
    v_lshl_add_u32 v65, v2, 2, v65
    v_mul_u32_u24 v64, 384, v65
    v_and_b32_e64 v65, 1, v3
    v_lshl_add_u32 v64, v65, 3, v64
    v_lshrrev_b32_e64 v65, 3, v3
    v_bfe_u32 v66, v3, 1, 1
    v_lshl_add_u32 v65, v65, 1, v66
    v_and_b32 v66, 1, v2
    v_lshlrev_b32 v66, 2, v66
    v_xor_b32_e64 v65, v65, v66
    v_lshl_add_u32 v64, v65, 4, v64
    s_mul_i32 s54, s6, 12288
    s_add_u32 s54, s54, 30720
    v_add_u32 v64, s54, v64
    v_xor_b32 v65, 32, v64
    v_add_u32 v65, 768, v65
    v_xor_b32_e64 v66, 64, v64
    v_xor_b32 v67, 96, v64
    v_add_u32 v67, 768, v67
    ds_read_b64_tr_b16 v[160:161], v64 offset:0
    ds_read_b64_tr_b16 v[162:163], v65 offset:0
    ds_read_b64_tr_b16 v[168:169], v66 offset:0
    ds_read_b64_tr_b16 v[170:171], v67 offset:0
    ds_read_b64_tr_b16 v[176:177], v64 offset:128
    ds_read_b64_tr_b16 v[178:179], v65 offset:128
    ds_read_b64_tr_b16 v[184:185], v66 offset:128
    ds_read_b64_tr_b16 v[186:187], v67 offset:128
    ds_read_b64_tr_b16 v[192:193], v64 offset:256
    ds_read_b64_tr_b16 v[194:195], v65 offset:256
    ds_read_b64_tr_b16 v[200:201], v66 offset:256
    ds_read_b64_tr_b16 v[202:203], v67 offset:256
    s_cmp_ge_u32 s6, 3
    s_cbranch_scc1 L_qg03_31
    s_branch L_qg0w_29
L_qg0r_30:
    s_cmp_lg_u32 s3, 0
    s_cbranch_scc1 L_rp_34
    v_cmp_ne_u32 vcc, 0, v59
    s_cmp_lg_u64 vcc, 0
    s_cbranch_scc1 L_rp_34
    v_readfirstlane_b32 s54, v58
    s_nop 1
    v_cmp_ne_u32 vcc, s54, v58
    s_cmp_eq_u64 vcc, 0
    s_cbranch_scc1 L_rp_34
    v_mov_b32 v61, s63
    v_mov_b32 v63, s63
    v_mov_b32 v65, s63
    v_mov_b32 v67, s63
    v_mov_b32 v60, v96
    v_mov_b32 v62, v97
    v_mov_b32 v64, v98
    v_mov_b32 v66, v99
    s_mov_b64 exec, s[34:35]
    buffer_store_dwordx4 v[60:63], v108, s[8:11], 0 offen offset:0 sc1
    buffer_store_dwordx4 v[64:67], v108, s[8:11], 0 offen offset:16 sc1
    s_mov_b64 exec, -1
    v_mov_b32 v60, v100
    v_mov_b32 v62, v101
    v_mov_b32 v64, v102
    v_mov_b32 v66, v103
    s_mov_b64 exec, s[34:35]
    buffer_store_dwordx4 v[60:63], v108, s[8:11], 0 offen offset:128 sc1
    buffer_store_dwordx4 v[64:67], v108, s[8:11], 0 offen offset:144 sc1
    s_mov_b64 exec, -1
    v_mov_b32 v60, v104
    v_mov_b32 v62, v105
    v_mov_b32 v64, v106
    v_mov_b32 v66, v107
    s_mov_b64 exec, s[34:35]
    buffer_store_dwordx4 v[60:63], v108, s[8:11], 0 offen offset:256 sc1
    buffer_store_dwordx4 v[64:67], v108, s[8:11], 0 offen offset:272 sc1
    s_mov_b64 exec, -1
    s_mov_b32 s3, 1
L_rp_34:
    s_lshl_b32 s54, s6, 9
    s_add_u32 s54, s54, s45
    v_lshlrev_b32_e64 v56, 13, v2
    v_lshl_add_u32 v56, v3, 5, v56
    v_add_u32_e64 v56, s54, v56
    s_mov_b32 s55, 32768
    buffer_load_dwordx4 v[20:23], v56, s[8:11], 0 offen offset:0 sc1
    buffer_load_dwordx4 v[36:39], v56, s[8:11], 0 offen offset:1536 sc1
    buffer_load_dwordx4 v[24:27], v56, s[8:11], 0 offen offset:16 sc1
    buffer_load_dwordx4 v[40:43], v56, s[8:11], 0 offen offset:1552 sc1
    buffer_load_dwordx4 v[28:31], v56, s[8:11], s55 offen offset:0 sc1
    buffer_load_dwordx4 v[44:47], v56, s[8:11], s55 offen offset:1536 sc1
    buffer_load_dwordx4 v[32:35], v56, s[8:11], s55 offen offset:16 sc1
    buffer_load_dwordx4 v[48:51], v56, s[8:11], s55 offen offset:1552 sc1
    buffer_load_dwordx4 v[52:55], v10, s[8:11], 0 offen offset:3072 sc1
    buffer_load_dwordx2 v[58:59], v10, s[8:11], 0 offen offset:3088 sc1
    s_add_u32 s47, s47, 1
    s_cmp_lt_u32 s47, 0x40000
    s_cbranch_scc1 L_qg0w_29
    s_branch L_end
L_qg0w_29:
    s_waitcnt vmcnt(0)
    v_xor_b32 v57, s63, v21
    v_xor_b32 v23, s63, v23
    v_or_b32 v57, v57, v23
    v_xor_b32 v25, s63, v25
    v_or_b32 v57, v57, v25
    v_xor_b32 v27, s63, v27
    v_or_b32 v57, v57, v27
    v_xor_b32 v29, s63, v29
    v_or_b32 v57, v57, v29
    v_xor_b32 v31, s63, v31
    v_or_b32 v57, v57, v31
    v_xor_b32 v33, s63, v33
    v_or_b32 v57, v57, v33
    v_xor_b32 v35, s63, v35
    v_or_b32 v57, v57, v35
    v_xor_b32 v37, s63, v37
    v_or_b32 v57, v57, v37
    v_xor_b32 v39, s63, v39
    v_or_b32 v57, v57, v39
    v_xor_b32 v41, s63, v41
    v_or_b32 v57, v57, v41
    v_xor_b32 v43, s63, v43
    v_or_b32 v57, v57, v43
    v_xor_b32 v45, s63, v45
    v_or_b32 v57, v57, v45
    v_xor_b32 v47, s63, v47
    v_or_b32 v57, v57, v47
    v_xor_b32 v49, s63, v49
    v_or_b32 v57, v57, v49
    v_xor_b32 v51, s63, v51
    v_or_b32 v57, v57, v51
    v_xor_b32 v53, s63, v53
    v_or_b32 v57, v57, v53
    v_xor_b32 v55, s63, v55
    v_or_b32 v57, v57, v55
    v_xor_b32 v59, s63, v59
    v_or_b32 v57, v57, v59
    v_cmp_ne_u32 vcc, 0, v57
    s_cmp_lg_u64 vcc, 0
    s_cbranch_scc1 L_qg0r_30
    v_readfirstlane_b32 s54, v58
    s_nop 1
    v_cmp_ne_u32_e64 vcc, s54, v58
    s_cmp_eq_u64 vcc, 0
    s_cselect_b32 s54, 1, 0
    v_mov_b32 v56, 160672
    v_mov_b32_e64 v57, s54
    ds_write_b32 v56, v57
    v_add_f32 v60, v20, v28
    v_add_f32 v64, v36, v44
    v_add_f32 v61, v22, v30
    v_add_f32 v65, v38, v46
    v_add_f32 v62, v24, v32
    v_add_f32 v66, v40, v48
    v_add_f32 v63, v26, v34
    v_add_f32 v67, v42, v50
    v_mov_b32 v28, v52
    v_mov_b32 v29, v54
    v_permlane32_swap_b32 v64, v65
    v_permlane32_swap_b32 v66, v67
    v_add_f32 v64, v64, v65
    v_add_f32 v66, v66, v67
    s_nop 1
    v_permlane16_swap_b32 v64, v66
    v_add_f32 v14, v64, v66
    v_permlane32_swap_b32 v60, v61
    v_permlane32_swap_b32 v62, v63
    v_add_f32 v60, v60, v61
    v_add_f32 v62, v62, v63
    s_nop 1
    v_permlane16_swap_b32 v60, v62
    v_add_f32 v41, v60, v62
    v_add_f32_dpp v28, v28, v28 quad_perm:[1,0,3,2] row_mask:0xf bank_mask:0xf
    v_add_f32_dpp v29, v29, v29 quad_perm:[1,0,3,2] row_mask:0xf bank_mask:0xf
    s_nop 0
    v_add_f32_dpp v28, v28, v28 quad_perm:[2,3,0,1] row_mask:0xf bank_mask:0xf
    v_add_f32_dpp v29, v29, v29 quad_perm:[2,3,0,1] row_mask:0xf bank_mask:0xf
    s_nop 0
    v_add_f32_dpp v28, v28, v28 row_half_mirror row_mask:0xf bank_mask:0xf
    v_add_f32_dpp v29, v29, v29 row_half_mirror row_mask:0xf bank_mask:0xf
    v_mul_f32 v42, 0x3acccccd, v28
    v_mul_f32 v44, 0x3acccccd, v29
    v_fma_f32 v44, -v42, v42, v44
    v_max_f32_e64 v44, 0, v44
    v_add_f32 v44, 0x3727c5ac, v44
    v_rsq_f32_e64 v43, v44
    v_fma_f32 v41, -v42, v14, v41
    v_mul_f32 v41, 0x3dd53b95, v41
    v_mul_f32_e64 v41, v41, v43
    v_cvt_pk_bf16_f32 v41, v41, v41
    ds_write_b16 v68, v41
    s_cmp_lg_u32 s3, 0
    s_cbranch_scc1 L_rp_36
    v_cmp_ne_u32 vcc, 0, v59
    s_cmp_lg_u64 vcc, 0
    s_cbranch_scc1 L_rp_36
    v_readfirstlane_b32 s54, v58
    s_nop 1
    v_cmp_ne_u32 vcc, s54, v58
    s_cmp_eq_u64 vcc, 0
    s_cbranch_scc1 L_rp_36
    v_mov_b32 v61, s63
    v_mov_b32 v63, s63
    v_mov_b32 v65, s63
    v_mov_b32 v67, s63
    v_mov_b32 v60, v96
    v_mov_b32 v62, v97
    v_mov_b32 v64, v98
    v_mov_b32_e64 v66, v99
    s_mov_b64 exec, s[34:35]
    buffer_store_dwordx4 v[60:63], v108, s[8:11], 0 offen offset:0 sc1
    buffer_store_dwordx4 v[64:67], v108, s[8:11], 0 offen offset:16 sc1
    s_mov_b64 exec, -1
    v_mov_b32 v60, v100
    v_mov_b32 v62, v101
    v_mov_b32 v64, v102
    v_mov_b32 v66, v103
    s_mov_b64 exec, s[34:35]
    buffer_store_dwordx4 v[60:63], v108, s[8:11], 0 offen offset:128 sc1
    buffer_store_dwordx4 v[64:67], v108, s[8:11], 0 offen offset:144 sc1
    s_mov_b64 exec, -1
    v_mov_b32 v60, v104
    v_mov_b32 v62, v105
    v_mov_b32 v64, v106
    v_mov_b32 v66, v107
    s_mov_b64 exec, s[34:35]
    buffer_store_dwordx4 v[60:63], v108, s[8:11], 0 offen offset:256 sc1
    buffer_store_dwordx4 v[64:67], v108, s[8:11], 0 offen offset:272 sc1
    s_mov_b64 exec, -1
    s_mov_b32 s3, 1
L_rp_36:
    s_branch L_qgJ_5
L_qg03_31:
    s_cmp_lg_u32 s6, 3
    s_cbranch_scc1 L_qgJ_5
L_qg03w_32:
    s_waitcnt vmcnt(0)
    v_xor_b32 v59, s63, v59
    v_cmp_ne_u32 vcc, 0, v59
    s_cmp_lg_u64 vcc, 0
    s_cbranch_scc1 L_qg03r_33
    s_cmp_lg_u32 s3, 0
    s_cbranch_scc1 L_rp_38
    v_cmp_ne_u32 vcc, 0, v59
    s_cmp_lg_u64 vcc, 0
    s_cbranch_scc1 L_rp_38
    v_readfirstlane_b32 s54, v58
    s_nop 1
    v_cmp_ne_u32 vcc, s54, v58
    s_cmp_eq_u64 vcc, 0
    s_cbranch_scc1 L_rp_38
    v_mov_b32 v61, s63
    v_mov_b32 v63, s63
    v_mov_b32 v65, s63
    v_mov_b32 v67, s63
    v_mov_b32 v60, v96
    v_mov_b32 v62, v97
    v_mov_b32 v64, v98
    v_mov_b32_e64 v66, v99
    s_mov_b64 exec, s[34:35]
    buffer_store_dwordx4 v[60:63], v108, s[8:11], 0 offen offset:0 sc1
    buffer_store_dwordx4 v[64:67], v108, s[8:11], 0 offen offset:16 sc1
    s_mov_b64 exec, -1
    v_mov_b32 v60, v100
    v_mov_b32 v62, v101
    v_mov_b32 v64, v102
    v_mov_b32 v66, v103
    s_mov_b64 exec, s[34:35]
    buffer_store_dwordx4 v[60:63], v108, s[8:11], 0 offen offset:128 sc1
    buffer_store_dwordx4 v[64:67], v108, s[8:11], 0 offen offset:144 sc1
    s_mov_b64 exec, -1
    v_mov_b32 v60, v104
    v_mov_b32 v62, v105
    v_mov_b32 v64, v106
    v_mov_b32 v66, v107
    s_mov_b64 exec, s[34:35]
    buffer_store_dwordx4 v[60:63], v108, s[8:11], 0 offen offset:256 sc1
    buffer_store_dwordx4 v[64:67], v108, s[8:11], 0 offen offset:272 sc1
    s_mov_b64 exec, -1
    s_mov_b32 s3, 1
L_rp_38:
    s_branch L_qgJ_5
L_qg03r_33:
    buffer_load_dwordx2 v[58:59], v10, s[8:11], 0 offen offset:3088 sc1
    s_add_u32 s47, s47, 1
    s_cmp_lt_u32 s47, 0x40000
    s_cbranch_scc1 L_qg03w_32
    s_branch L_end
L_pair:
    s_cmp_ge_u32 s6, 5
    s_cbranch_scc1 L_xs_40
L_pair2:
    v_cvt_pk_bf16_f32 v32, v30, v30
    ds_write_b16 v5, v32
    v_lshlrev_b32 v13, 16, v32
L_xs_40:
    s_waitcnt lgkmcnt(0)
    s_barrier
    s_cmp_ge_u32 s6, 4
    s_cbranch_scc1 L_q7_41
    ds_read_b128 v[20:23], v4 offset:0
    ds_read_b128 v[24:27], v4 offset:64
    ds_read_b128 v[28:31], v4 offset:128
    s_waitcnt lgkmcnt(0)
    v_mfma_f32_16x16x32_bf16 v[36:39], v[120:123], v[20:23], 0
    v_mfma_f32_16x16x32_bf16 v[36:39], v[124:127], v[24:27], v[36:39]
    v_mfma_f32_16x16x32_bf16 v[36:39], v[128:131], v[28:31], v[36:39]
    v_mfma_f32_16x16x32_bf16 v[40:43], v[132:135], v[20:23], 0
    v_mfma_f32_16x16x32_bf16 v[40:43], v[136:139], v[24:27], v[40:43]
    v_mfma_f32_16x16x32_bf16 v[40:43], v[140:143], v[28:31], v[40:43]
    v_mfma_f32_16x16x32_bf16 v[44:47], v[144:147], v[20:23], 0
    v_mfma_f32_16x16x32_bf16 v[44:47], v[148:151], v[24:27], v[44:47]
    v_mfma_f32_16x16x32_bf16 v[44:47], v[152:155], v[28:31], v[44:47]
    s_mov_b64 exec, s[32:33]
    s_cmp_eq_u32 s46, 0
    s_cbranch_scc1 L_slow_43
    buffer_store_dwordx4 v[36:39], v17, s[8:11], s49 offen
    s_nop 0
    buffer_store_dwordx4 v[40:43], v17, s[8:11], s49 offen offset:64
    s_nop 0
    s_nop 0
    buffer_store_dwordx4 v[44:47], v17, s[8:11], s49 offen offset:128
L_sd_44:
    s_mov_b64 exec, -1
    s_branch L_qe_42
L_q7_41:
    s_cmp_lg_u32 s6, 7
    s_cbranch_scc1 L_qe_42
    ds_read_b128 v[20:23], v4 offset:0
    ds_read_b128 v[24:27], v4 offset:64
    ds_read_b128 v[28:31], v4 offset:128
    v_mov_b32 v42, s44
    s_waitcnt lgkmcnt(0)
    v_mfma_f32_16x16x32_bf16 v[36:39], v[20:23], v[20:23], 0
    v_mfma_f32_16x16x32_bf16 v[36:39], v[24:27], v[24:27], v[36:39]
    v_mfma_f32_16x16x32_bf16 v[36:39], v[28:31], v[28:31], v[36:39]
    s_mov_b64 exec, 1
    s_cmp_eq_u32 s46, 0
    s_cbranch_scc1 L_slow_45
    s_nop 4
    buffer_store_dwordx2 v[36:37], v42, s[8:11], s49 offen offset:768
L_sd_46:
    s_mov_b64 exec, -1
L_qe_42:
    s_cmp_ge_u32 s6, 3
    s_cbranch_scc1 L_qgJ_5
    s_sleep 4
    buffer_load_dwordx4 v[20:23], v9, s[8:11], s49 offen sc1
    s_add_u32 s54, s49, 32768
    buffer_load_dwordx4 v[24:27], v9, s[8:11], s54 offen sc1
    buffer_load_dwordx2 v[28:29], v10, s[8:11], s49 offen offset:768 sc1
L_qg1w_47:
    s_nop 0
    s_waitcnt vmcnt(0)
    v_max3_u32 v40, v20, v21, v22
    v_max3_u32 v40, v40, v23, v24
    v_max3_u32 v40, v40, v25, v26
    v_max3_u32 v40, v40, v27, v28
    v_max_u32 v40, v40, v29
    v_add_f32 v20, v20, v24
    v_add_f32 v21, v21, v25
    v_add_f32 v22, v22, v26
    v_add_f32 v23, v23, v27
    v_cmp_eq_u32 vcc, -1, v40
    s_cmp_lg_u64 vcc, 0
    s_cbranch_scc1 L_qg1r_48
    v_permlane32_swap_b32 v20, v21
    v_permlane32_swap_b32 v22, v23
    v_add_f32_dpp v28, v28, v28 quad_perm:[1,0,3,2] row_mask:0xf bank_mask:0xf
    v_add_f32_dpp v29, v29, v29 quad_perm:[1,0,3,2] row_mask:0xf bank_mask:0xf
    v_add_f32 v20, v20, v21
    v_add_f32 v22, v22, v23
    v_add_f32_dpp v28, v28, v28 quad_perm:[2,3,0,1] row_mask:0xf bank_mask:0xf
    v_add_f32_dpp v29, v29, v29 quad_perm:[2,3,0,1] row_mask:0xf bank_mask:0xf
    v_permlane16_swap_b32 v20, v22
    v_add_f32_dpp v28, v28, v28 row_half_mirror row_mask:0xf bank_mask:0xf
    v_add_f32_dpp v29, v29, v29 row_half_mirror row_mask:0xf bank_mask:0xf
    v_add_f32 v41, v20, v22
    v_mul_f32 v42, 0x3acccccd, v29
    v_mul_f32 v44, 0x3acccccd, v28
    v_fma_f32 v44, -v42, v42, v44
    v_fma_f32 v41, -v42, v14, v41
    v_max_f32_e64 v44, 0, v44
    v_add_f32 v44, 0x3727c5ac, v44
    v_rsq_f32_e64 v43, v44
    v_mul_f32 v41, 0x3dd53b95, v41
    v_mul_f32_e64 v41, v41, v43
    v_cvt_pk_bf16_f32 v41, v41, v41
    ds_write_b16 v68, v41
L_qgJ_5:
    s_waitcnt lgkmcnt(0)
    s_barrier
    s_cmp_lg_u32 s7, 0
    s_cbranch_scc1 L_ff_49
    v_mov_b32 v66, 160672
    ds_read_b32 v67, v66
    s_waitcnt lgkmcnt(0)
    v_readfirstlane_b32 s46, v67
L_ff_49:
    ds_read_b128 v[20:23], v89
    ds_read_b128 v[24:27], v90
    ds_read_b128 v[28:31], v91
    ds_read_b128 v[32:35], v92
    ds_read_b128 v[36:39], v93
    ds_read_b128 v[40:43], v94
    v_mov_b32 v48, 0xff800000
    v_mov_b32 v44, 0
    v_mov_b32 v45, 0
    v_mov_b32 v46, 0
    v_mov_b32 v47, 0
    v_mov_b32 v52, 0
    v_mov_b32 v53, 0
    v_mov_b32 v54, 0
    v_mov_b32 v55, 0
    v_mov_b32 v56, 0
    v_mov_b32 v57, 0
    v_mov_b32 v58, 0
    v_mov_b32 v59, 0
    v_mov_b32 v60, 0
    v_mov_b32 v61, 0
    v_mov_b32 v62, 0
    v_mov_b32_e64 v63, 0
    s_waitcnt lgkmcnt(5)
    v_smfmac_f32_16x16x64_bf16 v[44:47], v[20:23], v[208:215], v95
    s_waitcnt lgkmcnt(4)
    v_smfmac_f32_16x16x64_bf16 v[44:47], v[24:27], v[216:223], v95
    s_waitcnt lgkmcnt(3)
    v_smfmac_f32_16x16x64_bf16 v[44:47], v[28:31], v[224:231], v95
    s_waitcnt lgkmcnt(2)
    v_smfmac_f32_16x16x64_bf16 v[44:47], v[32:35], v[232:239], v95
    s_waitcnt lgkmcnt(1)
    v_smfmac_f32_16x16x64_bf16 v[44:47], v[36:39], v[240:247], v95
    s_waitcnt lgkmcnt(0)
    v_smfmac_f32_16x16x64_bf16 v[44:47], v[40:43], v[248:255], v95
    s_nop 7
    v_add_f32 v44, v44, v46
    v_add_f32_e64 v45, v45, v47
    s_nop 0
    v_add_f32_dpp v48, v44, v45 row_ror:8 row_mask:0xf bank_mask:0xc
    s_nop 0
    s_nop 0
    v_max_f32_dpp v49, v48, v48 quad_perm:[1,0,3,2] row_mask:0xf bank_mask:0xf
    s_nop 0
    s_nop 0
    v_max_f32_dpp v49, v49, v49 quad_perm:[2,3,0,1] row_mask:0xf bank_mask:0xf
    s_nop 0
    s_nop 0
    v_max_f32_dpp v49, v49, v49 row_half_mirror row_mask:0xf bank_mask:0xf
    s_nop 0
    s_nop 0
    v_max_f32_dpp v49, v49, v49 row_bcast:15 row_mask:0xa bank_mask:0xf
    s_nop 0
    s_nop 0
    v_max_f32_dpp v49, v49, v49 row_bcast:31 row_mask:0xc bank_mask:0xf
    s_nop 0
    v_readlane_b32 s48, v49, 63
    s_nop 1
    v_subrev_f32 v48, s48, v48
    v_mov_b32 v65, s48
    v_exp_f32 v48, v48
    s_mov_b64 exec, 1
    ds_write_b32 v73, v65
    s_mov_b64 exec, -1
    v_mov_b32_dpp v50, v48 row_shl:1 row_mask:0xf bank_mask:0xf
    v_cvt_pk_bf16_f32 v50, v48, v50
    v_mov_b32 v64, v48
    s_cmp_lg_u32 s7, 0
    s_cbranch_scc1 L_v1_50
    v_bfe_u32 v33, v3, 2, 1
    v_lshl_add_u32 v33, v2, 2, v33
    v_mul_u32_u24 v32, 384, v33
    v_and_b32_e64 v33, 1, v3
    v_lshl_add_u32 v32, v33, 3, v32
    v_lshrrev_b32_e64 v33, 3, v3
    v_bfe_u32 v34, v3, 1, 1
    v_lshl_add_u32 v33, v33, 1, v34
    v_and_b32 v34, 1, v2
    v_lshlrev_b32 v34, 2, v34
    v_xor_b32_e64 v33, v33, v34
    v_lshl_add_u32 v32, v33, 4, v32
    s_mul_i32 s54, s6, 12288
    s_add_u32 s54, s54, 36864
    v_add_u32 v32, s54, v32
    v_xor_b32 v33, 32, v32
    v_add_u32 v33, 768, v33
    v_xor_b32_e64 v34, 64, v32
    v_xor_b32 v35, 96, v32
    v_add_u32 v35, 768, v35
    s_cmp_lg_u32 s6, 4
    s_cbranch_scc1 L_ld_51
    s_mul_i32 s56, s4, 245760
    s_add_u32 s56, s56, s62
    s_add_u32 s24, s72, s56
    s_addc_u32 s25, s73, 0
    s_sub_u32 s26, 7864320, s56
    s_mov_b32 s27, 0x20000
    v_add_u32 v45, 0, v1
    v_mul_u32_u24 v46, 6554, v45
    v_lshrrev_b32 v46, 16, v46
    v_mul_u32_u24 v47, 10, v46
    v_sub_u32_e64 v47, v45, v47
    v_mul_u32_u24 v46, 1280, v46
    v_lshl_add_u32 v40, v47, 4, v46
    v_add_u32_e64 v45, 64, v1
    v_mul_u32_u24 v46, 6554, v45
    v_lshrrev_b32 v46, 16, v46
    v_mul_u32_u24 v47, 10, v46
    v_sub_u32_e64 v47, v45, v47
    v_mul_u32_u24 v46, 1280, v46
    v_lshl_add_u32 v41, v47, 4, v46
    v_add_u32 v45, 128, v1
    v_mul_u32_u24 v46, 6554, v45
    v_lshrrev_b32 v46, 16, v46
    v_mul_u32_u24 v47, 10, v46
    v_sub_u32_e64 v47, v45, v47
    v_mul_u32_u24 v46, 1280, v46
    v_lshl_add_u32 v42, v47, 4, v46
    v_add_u32 v45, 192, v1
    v_mul_u32_u24 v46, 6554, v45
    v_lshrrev_b32 v46, 16, v46
    v_mul_u32_u24 v47, 10, v46
    v_sub_u32_e64 v47, v45, v47
    v_mul_u32_u24 v46, 1280, v46
    v_lshl_add_u32 v43, v47, 4, v46
    v_add_u32 v45, 256, v1
    v_mul_u32_u24 v46, 6554, v45
    v_lshrrev_b32 v46, 16, v46
    v_mul_u32_u24 v47, 10, v46
    v_sub_u32_e64 v47, v45, v47
    v_mul_u32_u24 v46, 1280, v46
    v_lshl_add_u32 v44, v47, 4, v46
    s_sub_u32 s59, s6, 4
    s_mul_i32 s56, s59, 30720
    s_add_u32 s56, s56, 129024
    s_mul_i32 s57, s59, 245760
    s_add_u32 s59, s56, 30720
.p2align 6
L_wo_52:
    s_add_u32 m0, s56, 0
    s_nop 0
    buffer_load_dwordx4 v40, s[24:27], s57 offen lds
    s_add_u32 m0, s56, 1024
    s_nop 0
    buffer_load_dwordx4 v41, s[24:27], s57 offen lds
    s_add_u32 m0, s56, 2048
    s_nop 0
    buffer_load_dwordx4 v42, s[24:27], s57 offen lds
    s_add_u32 m0, s56, 3072
    s_nop 0
    buffer_load_dwordx4 v43, s[24:27], s57 offen lds
    s_add_u32 m0, s56, 4096
    s_nop 0
    buffer_load_dwordx4 v44, s[24:27], s57 offen lds
    s_add_u32 s56, s56, 5120
    s_add_u32 s57, s57, 40960
    s_cmp_lt_u32 s56, s59
    s_cbranch_scc1 L_wo_52
    s_waitcnt vmcnt(30)
    s_setprio 0
L_ld_51:
    s_barrier
    ds_read_b64_tr_b16 v[164:165], v32 offset:0
    ds_read_b64_tr_b16 v[166:167], v33 offset:0
    ds_read_b64_tr_b16 v[172:173], v34 offset:0
    ds_read_b64_tr_b16 v[174:175], v35 offset:0
    ds_read_b64_tr_b16 v[180:181], v32 offset:128
    ds_read_b64_tr_b16 v[182:183], v33 offset:128
    ds_read_b64_tr_b16 v[188:189], v34 offset:128
    ds_read_b64_tr_b16 v[190:191], v35 offset:128
    ds_read_b64_tr_b16 v[196:197], v32 offset:256
    ds_read_b64_tr_b16 v[198:199], v33 offset:256
    ds_read_b64_tr_b16 v[204:205], v34 offset:256
    ds_read_b64_tr_b16 v[206:207], v35 offset:256
    s_waitcnt lgkmcnt(0)
L_v1_50:
    v_mov_b32_dpp v80, v50 row_newbcast:8 row_mask:0xf bank_mask:0x3
    v_mov_b32_dpp v81, v50 row_newbcast:10 row_mask:0xf bank_mask:0x3
    v_mov_b32_dpp v82, v50 row_newbcast:12 row_mask:0xf bank_mask:0x3
    v_mov_b32_dpp v83, v50 row_newbcast:14 row_mask:0xf bank_mask:0x3
    s_nop 0
    s_nop 0
    v_smfmac_f32_16x16x64_bf16 v[52:55], v[80:83], v[160:167], v88
    v_smfmac_f32_16x16x64_bf16 v[56:59], v[80:83], v[176:183], v88
    v_smfmac_f32_16x16x64_bf16 v[60:63], v[80:83], v[192:199], v88
    v_mov_b32_dpp v84, v50 row_newbcast:8 row_mask:0xf bank_mask:0xc
    v_mov_b32_dpp v85, v50 row_newbcast:10 row_mask:0xf bank_mask:0xc
    v_mov_b32_dpp v86, v50 row_newbcast:12 row_mask:0xf bank_mask:0xc
    v_mov_b32_dpp v87, v50 row_newbcast:14 row_mask:0xf bank_mask:0xc
    s_nop 0
    s_nop 0
    v_smfmac_f32_16x16x64_bf16 v[52:55], v[84:87], v[168:175], v88
    v_smfmac_f32_16x16x64_bf16 v[56:59], v[84:87], v[184:191], v88
    v_smfmac_f32_16x16x64_bf16 v[60:63], v[84:87], v[200:207], v88
    v_add_f32_dpp v64, v64, v64 quad_perm:[1,0,3,2] row_mask:0xf bank_mask:0xf
    s_nop 0
    s_nop 0
    v_add_f32_dpp v64, v64, v64 quad_perm:[2,3,0,1] row_mask:0xf bank_mask:0xf
    s_nop 0
    s_nop 0
    v_add_f32_dpp v64, v64, v64 row_half_mirror row_mask:0xf bank_mask:0xf
    s_nop 0
    s_nop 0
    v_add_f32_dpp v64, v64, v64 row_bcast:15 row_mask:0xa bank_mask:0xf
    s_nop 0
    s_nop 0
    v_add_f32_dpp v64, v64, v64 row_bcast:31 row_mask:0xc bank_mask:0xf
    ds_write_b32 v71, v52 offset:0
    ds_write_b32 v71, v56 offset:256
    ds_write_b32 v71, v60 offset:512
    s_mov_b64 exec, s[42:43]
    ds_write_b32 v73, v64 offset:64
    s_mov_b64 exec, -1
    s_cmp_lg_u32 s7, 0
    s_cbranch_scc1 L_hs0_53
    s_cmp_lg_u32 s6, 7
    s_cbranch_scc1 L_hs_skip_56
L_hs_loop_55:
    s_nop 0
    s_waitcnt vmcnt(0)
    v_add_u32_dpp v96, v96, v96 quad_perm:[1,0,3,2] row_mask:0xf bank_mask:0xf
    s_nop 0
    s_nop 0
    v_add_u32_dpp v96, v96, v96 quad_perm:[2,3,0,1] row_mask:0xf bank_mask:0xf
    s_nop 0
    s_nop 0
    v_add_u32_dpp v96, v96, v96 row_half_mirror row_mask:0xf bank_mask:0xf
    s_nop 0
    v_readfirstlane_b32 s56, v96
    s_cmp_ge_u32 s56, 256
    s_cbranch_scc1 L_hs_ok_54
    s_sleep 16
    v_and_b32 v97, 7, v1
    v_lshlrev_b32 v97, 5, v97
    buffer_load_dword v96, v97, s[12:15], 0 offen sc1
    s_add_u32 s47, s47, 1
    s_cmp_lt_u32 s47, 0x40000
    s_cbranch_scc1 L_hs_loop_55
    s_branch L_end
L_hs_ok_54:
L_hs_skip_56:
L_hs0_53:
    s_waitcnt lgkmcnt(0)
    s_barrier
    s_cmp_ge_u32 s6, 4
    s_cbranch_scc1 L_fc_57
    ds_read_b32 v28, v19
    s_cmp_eq_u32 s6, 3
    s_cbranch_scc1 L_ml_58
    ds_read_b32 v20, v77 offset:0
    ds_read_b32 v21, v77 offset:12288
    ds_read_b32 v22, v77 offset:24576
    ds_read_b32 v23, v77 offset:36864
    ds_read_b32 v24, v77 offset:49152
    ds_read_b32 v25, v78 offset:0
    ds_read_b32 v26, v78 offset:12288
    ds_read_b32 v27, v78 offset:24576
    s_waitcnt lgkmcnt(8)
    v_max_f32_dpp v29, v28, v28 quad_perm:[1,0,3,2] row_mask:0xf bank_mask:0xf
    s_nop 0
    s_nop 0
    v_max_f32_dpp v29, v29, v29 quad_perm:[2,3,0,1] row_mask:0xf bank_mask:0xf
    s_nop 0
    s_nop 0
    v_max_f32_dpp v29, v29, v29 row_half_mirror row_mask:0xf bank_mask:0xf
    v_sub_f32 v29, v28, v29
    v_exp_f32 v29, v29
    s_waitcnt lgkmcnt(0)
    s_nop 0
    v_mul_f32_dpp v30, v29, v20 row_newbcast:0 row_mask:0xf bank_mask:0xf
    v_fmac_f32_dpp v30, v29, v21 row_newbcast:1 row_mask:0xf bank_mask:0xf
    v_fmac_f32_dpp v30, v29, v22 row_newbcast:2 row_mask:0xf bank_mask:0xf
    v_fmac_f32_dpp v30, v29, v23 row_newbcast:3 row_mask:0xf bank_mask:0xf
    v_fmac_f32_dpp v30, v29, v24 row_newbcast:4 row_mask:0xf bank_mask:0xf
    v_fmac_f32_dpp v30, v29, v25 row_newbcast:5 row_mask:0xf bank_mask:0xf
    v_fmac_f32_dpp v30, v29, v26 row_newbcast:6 row_mask:0xf bank_mask:0xf
    v_fmac_f32_dpp v30, v29, v27 row_newbcast:7 row_mask:0xf bank_mask:0xf
    s_nop 0
    s_nop 0
    v_mov_b32_dpp v21, v30 row_shl:1 row_mask:0xf bank_mask:0xf
    v_cvt_pk_bf16_f32 v22, v30, v21
    s_nop 0
    s_nop 0
    v_mov_b32_dpp v23, v22 row_shl:2 row_mask:0xf bank_mask:0xf
    v_min_u32 v22, 0xfffffffe, v22
    v_min_u32_e64 v23, 0xfffffffe, v23
    s_mov_b64 exec, s[36:37]
    s_cmp_eq_u32 s46, 0
    s_cbranch_scc1 L_slow_59
    buffer_store_dwordx2 v[22:23], v72, s[8:11], s50 offen
L_sd_60:
    s_mov_b64 exec, -1
    s_branch L_fc_57
L_ml_58:
    ds_read_b32 v21, v19 offset:64
    v_mov_b32 v33, s44
    s_waitcnt lgkmcnt(0)
    v_max_f32_dpp v20, v28, v28 quad_perm:[1,0,3,2] row_mask:0xf bank_mask:0xf
    s_nop 0
    s_nop 0
    v_max_f32_dpp v20, v20, v20 quad_perm:[2,3,0,1] row_mask:0xf bank_mask:0xf
    s_nop 0
    s_nop 0
    v_max_f32_dpp v20, v20, v20 row_half_mirror row_mask:0xf bank_mask:0xf
    v_sub_f32 v29, v28, v20
    v_exp_f32 v29, v29
    s_nop 0
    v_mul_f32 v21, v21, v29
    s_nop 0
    s_nop 0
    v_add_f32_dpp v21, v21, v21 quad_perm:[1,0,3,2] row_mask:0xf bank_mask:0xf
    s_nop 0
    s_nop 0
    v_add_f32_dpp v21, v21, v21 quad_perm:[2,3,0,1] row_mask:0xf bank_mask:0xf
    s_nop 0
    s_nop 0
    v_add_f32_dpp v21, v21, v21 row_half_mirror row_mask:0xf bank_mask:0xf
    s_mov_b64 exec, 1
    s_cmp_eq_u32 s46, 0
    s_cbranch_scc1 L_slow_61
    buffer_store_dwordx2 v[20:21], v33, s[8:11], s50 offen offset:384
L_sd_62:
    s_mov_b64 exec, -1
L_fc_57:
    s_cmp_lt_u32 s6, 5
    s_cbranch_scc1 L_o_ng_63
    v_lshrrev_b32 v28, 3, v1
    v_lshlrev_b32 v28, 3, v28
    v_add_u32 v28, 34944, v28
    s_nop 0
    s_sleep 5
    buffer_load_dwordx4 v[20:23], v0, s[8:11], s50 offen sc1
    buffer_load_dwordx2 v[24:25], v156, s[8:11], s50 offen offset:384 sc1
L_o_w_64:
    s_nop 0
    s_waitcnt vmcnt(0)
    v_max3_u32 v27, v20, v21, v22
    v_max3_u32 v27, v27, v23, v24
    v_max_u32 v27, v27, v25
    v_cmp_eq_u32 vcc, -1, v27
    s_cmp_lg_u64 vcc, 0
    s_cbranch_scc1 L_o_r_65
    ds_write_b128 v157, v[20:23]
    ds_write_b64 v28, v[24:25]
    s_branch L_o_pf_67
L_o_ng_63:
    s_cmp_eq_u32 s7, 0
    s_cbranch_scc1 L_o_pf_67
    v_lshrrev_b32 v65, 2, v3
    v_lshl_add_u32 v65, v2, 2, v65
    v_mul_u32_u24 v64, 160, v65
    v_and_b32_e64 v66, 3, v3
    v_lshl_add_u32 v64, v66, 3, v64
    s_lshl_b32 s54, s6, 5
    s_add_u32 s54, s54, 129024
    v_add_u32 v64, s54, v64
    ds_read_b64_tr_b16 v[96:97], v64 offset:0
    ds_read_b64_tr_b16 v[98:99], v64 offset:2560
    ds_read_b64_tr_b16 v[100:101], v64 offset:5120
    ds_read_b64_tr_b16 v[102:103], v64 offset:7680
    ds_read_b64_tr_b16 v[104:105], v64 offset:10240
    ds_read_b64_tr_b16 v[106:107], v64 offset:12800
    ds_read_b64_tr_b16 v[108:109], v64 offset:15360
    ds_read_b64_tr_b16 v[110:111], v64 offset:17920
    ds_read_b64_tr_b16 v[112:113], v64 offset:20480
    ds_read_b64_tr_b16 v[114:115], v64 offset:23040
    ds_read_b64_tr_b16 v[116:117], v64 offset:25600
    ds_read_b64_tr_b16 v[118:119], v64 offset:28160
L_o_pf_67:
    s_cmp_lg_u32 s7, 0
    s_cbranch_scc1 L_o_wl_68
    s_cmp_lg_u32 s6, 4
    s_cbranch_scc1 L_ld_69
    s_waitcnt vmcnt(0)
L_ld_69:
L_o_wl_68:
    s_waitcnt lgkmcnt(0)
    s_barrier
    s_cmp_lg_u32 s7, 0
    s_cbranch_scc1 L_o_p0_70
    s_cmp_lt_u32 s6, 5
    s_cbranch_scc1 L_o_x_71
    s_mul_i32 s56, s5, 245760
    s_mul_i32 s57, s4, 96
    s_add_u32 s56, s56, s57
    s_cmp_eq_u32 s6, 6
    s_cbranch_scc1 L_g6_72
    s_cmp_eq_u32 s6, 7
    s_cbranch_scc1 L_g7_73
    s_add_u32 s24, s76, s56
    s_addc_u32 s25, s77, 0
    s_sub_u32 s26, 1966080, s56
    s_mov_b32 s27, 0x20000
    s_mov_b32 s54, 0
    s_lshl_b32 s58, s54, 6
    v_add_u32_e64 v60, s58, v1
    v_min_u32 v60, 479, v60
    v_mul_u32_u24 v61, 10923, v60
    v_lshrrev_b32 v61, 16, v61
    v_mul_u32_u24 v62, 6, v61
    v_sub_u32_e64 v62, v60, v62
    v_mul_u32_u24 v61, 3072, v61
    v_lshl_add_u32 v63, v62, 4, v61
    s_lshl_b32 s58, s54, 10
    s_add_u32 m0, s58, 0
    s_nop 0
    buffer_load_dwordx4 v63, s[24:27], 0 offen lds
    s_mov_b32 s54, 1
    s_lshl_b32 s58, s54, 6
    v_add_u32 v60, s58, v1
    v_min_u32 v60, 479, v60
    v_mul_u32_u24 v61, 10923, v60
    v_lshrrev_b32 v61, 16, v61
    v_mul_u32_u24 v62, 6, v61
    v_sub_u32_e64 v62, v60, v62
    v_mul_u32_u24 v61, 3072, v61
    v_lshl_add_u32 v63, v62, 4, v61
    s_lshl_b32 s58, s54, 10
    s_add_u32 m0, s58, 0
    s_nop 0
    buffer_load_dwordx4 v63, s[24:27], 0 offen lds
    s_mov_b32 s54, 2
    s_lshl_b32 s58, s54, 6
    v_add_u32 v60, s58, v1
    v_min_u32 v60, 479, v60
    v_mul_u32_u24 v61, 10923, v60
    v_lshrrev_b32 v61, 16, v61
    v_mul_u32_u24 v62, 6, v61
    v_sub_u32_e64 v62, v60, v62
    v_mul_u32_u24 v61, 3072, v61
    v_lshl_add_u32 v63, v62, 4, v61
    s_lshl_b32 s58, s54, 10
    s_add_u32 m0, s58, 0
    s_nop 0
    buffer_load_dwordx4 v63, s[24:27], 0 offen lds
    s_mov_b32 s54, 3
    s_lshl_b32 s58, s54, 6
    v_add_u32 v60, s58, v1
    v_min_u32 v60, 479, v60
    v_mul_u32_u24 v61, 10923, v60
    v_lshrrev_b32 v61, 16, v61
    v_mul_u32_u24 v62, 6, v61
    v_sub_u32_e64 v62, v60, v62
    v_mul_u32_u24 v61, 3072, v61
    v_lshl_add_u32 v63, v62, 4, v61
    s_lshl_b32 s58, s54, 10
    s_add_u32 m0, s58, 0
    s_nop 0
    buffer_load_dwordx4 v63, s[24:27], 0 offen lds
    s_mov_b32 s54, 4
    s_lshl_b32 s58, s54, 6
    v_add_u32 v60, s58, v1
    v_min_u32 v60, 479, v60
    v_mul_u32_u24 v61, 10923, v60
    v_lshrrev_b32 v61, 16, v61
    v_mul_u32_u24 v62, 6, v61
    v_sub_u32_e64 v62, v60, v62
    v_mul_u32_u24 v61, 3072, v61
    v_lshl_add_u32 v63, v62, 4, v61
    s_lshl_b32 s58, s54, 10
    s_add_u32 m0, s58, 0
    s_nop 0
    buffer_load_dwordx4 v63, s[24:27], 0 offen lds
    s_mov_b32 s54, 5
    s_lshl_b32 s58, s54, 6
    v_add_u32 v60, s58, v1
    v_min_u32 v60, 479, v60
    v_mul_u32_u24 v61, 10923, v60
    v_lshrrev_b32 v61, 16, v61
    v_mul_u32_u24 v62, 6, v61
    v_sub_u32_e64 v62, v60, v62
    v_mul_u32_u24 v61, 3072, v61
    v_lshl_add_u32 v63, v62, 4, v61
    s_lshl_b32 s58, s54, 10
    s_add_u32 m0, s58, 0
    s_nop 0
    buffer_load_dwordx4 v63, s[24:27], 0 offen lds
    s_mov_b32 s54, 6
    s_lshl_b32 s58, s54, 6
    v_add_u32 v60, s58, v1
    v_min_u32 v60, 479, v60
    v_mul_u32_u24 v61, 10923, v60
    v_lshrrev_b32 v61, 16, v61
    v_mul_u32_u24 v62, 6, v61
    v_sub_u32_e64 v62, v60, v62
    v_mul_u32_u24 v61, 3072, v61
    v_lshl_add_u32 v63, v62, 4, v61
    s_lshl_b32 s58, s54, 10
    s_add_u32 m0, s58, 0
    s_nop 0
    buffer_load_dwordx4 v63, s[24:27], 0 offen lds
    s_mov_b32 s54, 7
    s_lshl_b32 s58, s54, 6
    v_add_u32 v60, s58, v1
    v_min_u32 v60, 479, v60
    v_mul_u32_u24 v61, 10923, v60
    v_lshrrev_b32 v61, 16, v61
    v_mul_u32_u24 v62, 6, v61
    v_sub_u32_e64 v62, v60, v62
    v_mul_u32_u24 v61, 3072, v61
    v_lshl_add_u32 v63, v62, 4, v61
    s_lshl_b32 s58, s54, 10
    s_add_u32 m0, s58, 0
    s_nop 0
    buffer_load_dwordx4 v63, s[24:27], 0 offen lds
    s_branch L_ge_74
L_g6_72:
    s_add_u32 s24, s78, s56
    s_addc_u32 s25, s79, 0
    s_sub_u32 s26, 1966080, s56
    s_mov_b32 s27, 0x20000
    s_mov_b32 s54, 0
    s_lshl_b32 s58, s54, 6
    v_add_u32_e64 v60, s58, v1
    v_min_u32 v60, 479, v60
    v_mul_u32_u24 v61, 10923, v60
    v_lshrrev_b32 v61, 16, v61
    v_mul_u32_u24 v62, 6, v61
    v_sub_u32_e64 v62, v60, v62
    v_mul_u32_u24 v61, 3072, v61
    v_lshl_add_u32 v63, v62, 4, v61
    s_lshl_b32 s58, s54, 10
    s_add_u32 m0, s58, 8192
    s_nop 0
    buffer_load_dwordx4 v63, s[24:27], 0 offen lds
    s_mov_b32 s54, 1
    s_lshl_b32 s58, s54, 6
    v_add_u32_e64 v60, s58, v1
    v_min_u32 v60, 479, v60
    v_mul_u32_u24 v61, 10923, v60
    v_lshrrev_b32 v61, 16, v61
    v_mul_u32_u24 v62, 6, v61
    v_sub_u32_e64 v62, v60, v62
    v_mul_u32_u24 v61, 3072, v61
    v_lshl_add_u32 v63, v62, 4, v61
    s_lshl_b32 s58, s54, 10
    s_add_u32 m0, s58, 8192
    s_nop 0
    buffer_load_dwordx4 v63, s[24:27], 0 offen lds
    s_mov_b32 s54, 2
    s_lshl_b32 s58, s54, 6
    v_add_u32_e64 v60, s58, v1
    v_min_u32 v60, 479, v60
    v_mul_u32_u24 v61, 10923, v60
    v_lshrrev_b32 v61, 16, v61
    v_mul_u32_u24 v62, 6, v61
    v_sub_u32_e64 v62, v60, v62
    v_mul_u32_u24 v61, 3072, v61
    v_lshl_add_u32 v63, v62, 4, v61
    s_lshl_b32 s58, s54, 10
    s_add_u32 m0, s58, 8192
    s_nop 0
    buffer_load_dwordx4 v63, s[24:27], 0 offen lds
    s_mov_b32 s54, 3
    s_lshl_b32 s58, s54, 6
    v_add_u32_e64 v60, s58, v1
    v_min_u32 v60, 479, v60
    v_mul_u32_u24 v61, 10923, v60
    v_lshrrev_b32 v61, 16, v61
    v_mul_u32_u24 v62, 6, v61
    v_sub_u32_e64 v62, v60, v62
    v_mul_u32_u24 v61, 3072, v61
    v_lshl_add_u32 v63, v62, 4, v61
    s_lshl_b32 s58, s54, 10
    s_add_u32 m0, s58, 8192
    s_nop 0
    buffer_load_dwordx4 v63, s[24:27], 0 offen lds
    s_mov_b32 s54, 4
    s_lshl_b32 s58, s54, 6
    v_add_u32_e64 v60, s58, v1
    v_min_u32 v60, 479, v60
    v_mul_u32_u24 v61, 10923, v60
    v_lshrrev_b32 v61, 16, v61
    v_mul_u32_u24 v62, 6, v61
    v_sub_u32_e64 v62, v60, v62
    v_mul_u32_u24 v61, 3072, v61
    v_lshl_add_u32 v63, v62, 4, v61
    s_lshl_b32 s58, s54, 10
    s_add_u32 m0, s58, 8192
    s_nop 0
    buffer_load_dwordx4 v63, s[24:27], 0 offen lds
    s_mov_b32 s54, 5
    s_lshl_b32 s58, s54, 6
    v_add_u32_e64 v60, s58, v1
    v_min_u32 v60, 479, v60
    v_mul_u32_u24 v61, 10923, v60
    v_lshrrev_b32 v61, 16, v61
    v_mul_u32_u24 v62, 6, v61
    v_sub_u32_e64 v62, v60, v62
    v_mul_u32_u24 v61, 3072, v61
    v_lshl_add_u32 v63, v62, 4, v61
    s_lshl_b32 s58, s54, 10
    s_add_u32 m0, s58, 8192
    s_nop 0
    buffer_load_dwordx4 v63, s[24:27], 0 offen lds
    s_mov_b32 s54, 6
    s_lshl_b32 s58, s54, 6
    v_add_u32_e64 v60, s58, v1
    v_min_u32 v60, 479, v60
    v_mul_u32_u24 v61, 10923, v60
    v_lshrrev_b32 v61, 16, v61
    v_mul_u32_u24 v62, 6, v61
    v_sub_u32_e64 v62, v60, v62
    v_mul_u32_u24 v61, 3072, v61
    v_lshl_add_u32 v63, v62, 4, v61
    s_lshl_b32 s58, s54, 10
    s_add_u32 m0, s58, 8192
    s_nop 0
    buffer_load_dwordx4 v63, s[24:27], 0 offen lds
    s_mov_b32 s54, 7
    s_lshl_b32 s58, s54, 6
    v_add_u32_e64 v60, s58, v1
    v_min_u32 v60, 479, v60
    v_mul_u32_u24 v61, 10923, v60
    v_lshrrev_b32 v61, 16, v61
    v_mul_u32_u24 v62, 6, v61
    v_sub_u32_e64 v62, v60, v62
    v_mul_u32_u24 v61, 3072, v61
    v_lshl_add_u32 v63, v62, 4, v61
    s_lshl_b32 s58, s54, 10
    s_add_u32 m0, s58, 8192
    s_nop 0
    buffer_load_dwordx4 v63, s[24:27], 0 offen lds
    s_branch L_ge_74
L_g7_73:
    s_mul_i32 s56, s4, 61440
    s_add_u32 s56, s56, s62
    s_add_u32 s24, s80, s56
    s_addc_u32 s25, s81, 0
    s_sub_u32 s26, 1966080, s56
    s_mov_b32 s27, 0x20000
    s_mov_b32 s54, 0
    s_lshl_b32 s58, s54, 6
    v_add_u32_e64 v60, s58, v1
    v_min_u32 v60, 479, v60
    v_mul_u32_u24 v61, 6554, v60
    v_lshrrev_b32 v61, 16, v61
    v_mul_u32_u24 v62, 10, v61
    v_sub_u32_e64 v62, v60, v62
    v_mul_u32_u24 v61, 1280, v61
    v_lshl_add_u32 v63, v62, 4, v61
    s_lshl_b32 s58, s54, 10
    s_add_u32 m0, s58, 16384
    s_nop 0
    buffer_load_dwordx4 v63, s[24:27], 0 offen lds
    s_mov_b32 s54, 1
    s_lshl_b32 s58, s54, 6
    v_add_u32_e64 v60, s58, v1
    v_min_u32 v60, 479, v60
    v_mul_u32_u24 v61, 6554, v60
    v_lshrrev_b32 v61, 16, v61
    v_mul_u32_u24 v62, 10, v61
    v_sub_u32_e64 v62, v60, v62
    v_mul_u32_u24 v61, 1280, v61
    v_lshl_add_u32 v63, v62, 4, v61
    s_lshl_b32 s58, s54, 10
    s_add_u32 m0, s58, 16384
    s_nop 0
    buffer_load_dwordx4 v63, s[24:27], 0 offen lds
    s_mov_b32 s54, 2
    s_lshl_b32 s58, s54, 6
    v_add_u32_e64 v60, s58, v1
    v_min_u32 v60, 479, v60
    v_mul_u32_u24 v61, 6554, v60
    v_lshrrev_b32 v61, 16, v61
    v_mul_u32_u24 v62, 10, v61
    v_sub_u32_e64 v62, v60, v62
    v_mul_u32_u24 v61, 1280, v61
    v_lshl_add_u32 v63, v62, 4, v61
    s_lshl_b32 s58, s54, 10
    s_add_u32 m0, s58, 16384
    s_nop 0
    buffer_load_dwordx4 v63, s[24:27], 0 offen lds
    s_mov_b32 s54, 3
    s_lshl_b32 s58, s54, 6
    v_add_u32_e64 v60, s58, v1
    v_min_u32 v60, 479, v60
    v_mul_u32_u24 v61, 6554, v60
    v_lshrrev_b32 v61, 16, v61
    v_mul_u32_u24 v62, 10, v61
    v_sub_u32_e64 v62, v60, v62
    v_mul_u32_u24 v61, 1280, v61
    v_lshl_add_u32 v63, v62, 4, v61
    s_lshl_b32 s58, s54, 10
    s_add_u32 m0, s58, 16384
    s_nop 0
    buffer_load_dwordx4 v63, s[24:27], 0 offen lds
    s_mov_b32 s54, 4
    s_lshl_b32 s58, s54, 6
    v_add_u32_e64 v60, s58, v1
    v_min_u32 v60, 479, v60
    v_mul_u32_u24 v61, 6554, v60
    v_lshrrev_b32 v61, 16, v61
    v_mul_u32_u24 v62, 10, v61
    v_sub_u32_e64 v62, v60, v62
    v_mul_u32_u24 v61, 1280, v61
    v_lshl_add_u32 v63, v62, 4, v61
    s_lshl_b32 s58, s54, 10
    s_add_u32 m0, s58, 16384
    s_nop 0
    buffer_load_dwordx4 v63, s[24:27], 0 offen lds
    s_mov_b32 s54, 5
    s_lshl_b32 s58, s54, 6
    v_add_u32_e64 v60, s58, v1
    v_min_u32 v60, 479, v60
    v_mul_u32_u24 v61, 6554, v60
    v_lshrrev_b32 v61, 16, v61
    v_mul_u32_u24 v62, 10, v61
    v_sub_u32_e64 v62, v60, v62
    v_mul_u32_u24 v61, 1280, v61
    v_lshl_add_u32 v63, v62, 4, v61
    s_lshl_b32 s58, s54, 10
    s_add_u32 m0, s58, 16384
    s_nop 0
    buffer_load_dwordx4 v63, s[24:27], 0 offen lds
    s_mov_b32 s54, 6
    s_lshl_b32 s58, s54, 6
    v_add_u32_e64 v60, s58, v1
    v_min_u32 v60, 479, v60
    v_mul_u32_u24 v61, 6554, v60
    v_lshrrev_b32 v61, 16, v61
    v_mul_u32_u24 v62, 10, v61
    v_sub_u32_e64 v62, v60, v62
    v_mul_u32_u24 v61, 1280, v61
    v_lshl_add_u32 v63, v62, 4, v61
    s_lshl_b32 s58, s54, 10
    s_add_u32 m0, s58, 16384
    s_nop 0
    buffer_load_dwordx4 v63, s[24:27], 0 offen lds
    s_mov_b32 s54, 7
    s_lshl_b32 s58, s54, 6
    v_add_u32_e64 v60, s58, v1
    v_min_u32 v60, 479, v60
    v_mul_u32_u24 v61, 6554, v60
    v_lshrrev_b32 v61, 16, v61
    v_mul_u32_u24 v62, 10, v61
    v_sub_u32_e64 v62, v60, v62
    v_mul_u32_u24 v61, 1280, v61
    v_lshl_add_u32 v63, v62, 4, v61
    s_lshl_b32 s58, s54, 10
    s_add_u32 m0, s58, 16384
    s_nop 0
    buffer_load_dwordx4 v63, s[24:27], 0 offen lds
L_ge_74:
    s_branch L_o_s2_66
L_o_x_71:
    v_lshrrev_b32 v65, 2, v3
    v_lshl_add_u32 v65, v2, 2, v65
    v_mul_u32_u24 v64, 160, v65
    v_and_b32_e64 v66, 3, v3
    v_lshl_add_u32 v64, v66, 3, v64
    s_lshl_b32 s54, s6, 5
    s_add_u32 s54, s54, 129024
    v_add_u32 v64, s54, v64
    ds_read_b64_tr_b16 v[96:97], v64 offset:0
    ds_read_b64_tr_b16 v[98:99], v64 offset:2560
    ds_read_b64_tr_b16 v[100:101], v64 offset:5120
    ds_read_b64_tr_b16 v[102:103], v64 offset:7680
    ds_read_b64_tr_b16 v[104:105], v64 offset:10240
    ds_read_b64_tr_b16 v[106:107], v64 offset:12800
    ds_read_b64_tr_b16 v[108:109], v64 offset:15360
    ds_read_b64_tr_b16 v[110:111], v64 offset:17920
    ds_read_b64_tr_b16 v[112:113], v64 offset:20480
    ds_read_b64_tr_b16 v[114:115], v64 offset:23040
    ds_read_b64_tr_b16 v[116:117], v64 offset:25600
    ds_read_b64_tr_b16 v[118:119], v64 offset:28160
L_o_p0_70:
    s_cmp_ge_u32 s6, 5
    s_cbranch_scc1 L_o_s2_66
    ds_read_b64 v[44:45], v159
    ds_read_b128 v[20:23], v158 offset:0
    ds_read_b128 v[24:27], v158 offset:64
    ds_read_b128 v[28:31], v158 offset:128
    ds_read_b128 v[32:35], v158 offset:192
    ds_read_b128 v[36:39], v158 offset:256
    ds_read_b128 v[40:43], v158 offset:320
    s_waitcnt lgkmcnt(6)
    v_max_f32_dpp v53, v44, v44 quad_perm:[1,0,3,2] row_mask:0xf bank_mask:0xf
    s_nop 1
    v_max_f32_dpp v53, v53, v53 quad_perm:[2,3,0,1] row_mask:0xf bank_mask:0xf
    s_nop 0
    s_nop 0
    v_max_f32_dpp v53, v53, v53 row_half_mirror row_mask:0xf bank_mask:0xf
    s_waitcnt lgkmcnt(5)
    v_mfma_f32_16x16x32_bf16 v[48:51], v[96:99], v[20:23], 0
    v_sub_f32_e64 v54, v44, v53
    s_waitcnt lgkmcnt(4)
    v_mfma_f32_16x16x32_bf16 v[48:51], v[100:103], v[24:27], v[48:51]
    v_exp_f32 v54, v54
    s_waitcnt lgkmcnt(3)
    v_mfma_f32_16x16x32_bf16 v[48:51], v[104:107], v[28:31], v[48:51]
    v_mul_f32 v53, v54, v45
    s_waitcnt lgkmcnt(2)
    v_mfma_f32_16x16x32_bf16 v[48:51], v[108:111], v[32:35], v[48:51]
    v_add_f32_dpp v53, v53, v53 quad_perm:[1,0,3,2] row_mask:0xf bank_mask:0xf
    s_waitcnt lgkmcnt(1)
    v_mfma_f32_16x16x32_bf16 v[48:51], v[112:115], v[36:39], v[48:51]
    v_add_f32_dpp v53, v53, v53 quad_perm:[2,3,0,1] row_mask:0xf bank_mask:0xf
    s_waitcnt lgkmcnt(0)
    v_mfma_f32_16x16x32_bf16 v[48:51], v[116:119], v[40:43], v[48:51]
    v_add_f32_dpp v53, v53, v53 row_half_mirror row_mask:0xf bank_mask:0xf
    v_rcp_f32 v53, v53
    s_nop 0
    v_mul_f32 v54, v54, v53
    s_nop 3
    v_mul_f32 v48, v48, v54
    v_mul_f32 v49, v49, v54
    v_mul_f32 v50, v50, v54
    v_mul_f32 v51, v51, v54
    v_add_f32_dpp v56, v48, v48 row_shl:4 row_mask:0xf bank_mask:0x5
    v_add_f32_dpp v57, v49, v49 row_shl:4 row_mask:0xf bank_mask:0x5
    v_add_f32_dpp v56, v50, v50 row_shr:4 row_mask:0xf bank_mask:0xa
    v_add_f32_dpp v57, v51, v51 row_shr:4 row_mask:0xf bank_mask:0xa
    s_nop 0
    v_add_f32_dpp v56, v56, v56 quad_perm:[1,0,3,2] row_mask:0xf bank_mask:0xf
    v_add_f32_dpp v57, v57, v57 quad_perm:[1,0,3,2] row_mask:0xf bank_mask:0xf
    s_nop 0
    v_add_f32_dpp v56, v56, v56 quad_perm:[2,3,0,1] row_mask:0xf bank_mask:0xf
    v_add_f32_dpp v57, v57, v57 quad_perm:[2,3,0,1] row_mask:0xf bank_mask:0xf
    s_mov_b64 exec, s[38:39]
    buffer_store_dwordx2 v[56:57], v7, s[8:11], s52 offen sc1
    s_mov_b64 exec, -1
L_o_s2_66:
    s_cmp_ge_u32 s6, 6
    s_cbranch_scc1 L_gua_77
    v_lshrrev_b32_e64 v65, 2, v3
    v_lshl_add_u32 v65, v2, 2, v65
    v_mul_u32_u24 v64, 96, v65
    v_and_b32_e64 v66, 3, v3
    v_lshl_add_u32 v64, v66, 3, v64
    s_cmp_ge_u32 s6, 3
    s_cselect_b32 s54, 8096, 0
    s_lshl_b32 s55, s6, 5
    s_add_u32 s54, s54, s55
    s_add_u32 s54, s54, 0
    v_add_u32 v64, s54, v64
    v_mov_b32 v106, 0
    v_mov_b32_e64 v107, 0
    s_cmp_eq_u32 s7, 0
    s_cbranch_scc1 L_gupf_78
    ds_read_b64_tr_b16 v[96:97], v64 offset:0
    ds_read_b64_tr_b16 v[98:99], v64 offset:1536
    ds_read_b64_tr_b16 v[100:101], v64 offset:3072
    ds_read_b64_tr_b16 v[102:103], v64 offset:4608
    ds_read_b64_tr_b16 v[104:105], v64 offset:6144
L_gupf_78:
L_gua_77:
    s_cmp_ge_u32 s6, 5
    s_cbranch_scc1 L_xw_76
    s_nop 0
    s_sleep 11
    buffer_load_dwordx4 v[20:23], v6, s[8:11], s52 offen sc1
    buffer_load_dwordx4 v[24:27], v6, s[8:11], s52 offen offset:1024 sc1
L_x_w_79:
    s_nop 0
    s_waitcnt vmcnt(0)
    v_max3_u32 v31, v20, v21, v22
    v_add_f32 v32, v20, v24
    v_add_f32 v33, v21, v25
    v_add_f32 v34, v22, v26
    v_add_f32 v35, v23, v27
    v_max3_u32 v31, v31, v23, v24
    v_add_f32_dpp v28, v32, v32 row_ror:8 row_mask:0xf bank_mask:0x3
    v_add_f32_dpp v29, v34, v34 row_ror:8 row_mask:0xf bank_mask:0x3
    v_add_f32_dpp v28, v33, v33 row_ror:8 row_mask:0xf bank_mask:0xc
    v_add_f32_dpp v29, v35, v35 row_ror:8 row_mask:0xf bank_mask:0xc
    v_max3_u32 v31, v31, v25, v26
    v_max_u32_e64 v31, v31, v27
    v_add_f32_dpp v30, v28, v28 row_shl:4 row_mask:0xf bank_mask:0x5
    v_add_f32_dpp v30, v29, v29 row_shr:4 row_mask:0xf bank_mask:0xa
    v_cmp_eq_u32_e64 vcc, -1, v31
    s_cmp_lg_u64 vcc, 0
    s_cbranch_scc1 L_x_r_80
    v_add_f32_dpp v30, v30, v30 quad_perm:[1,0,3,2] row_mask:0xf bank_mask:0xf
    s_nop 0
    s_nop 0
    v_add_f32_dpp v30, v30, v30 quad_perm:[2,3,0,1] row_mask:0xf bank_mask:0xf
    v_add_f32_e64 v30, v30, v13
    v_cvt_pk_bf16_f32 v32, v30, v30
    ds_write_b16 v5, v32
    v_lshlrev_b32 v13, 16, v32
L_xw_76:
    s_waitcnt vmcnt(0)
L_xs2_75:
    s_waitcnt lgkmcnt(0)
    s_barrier
    s_cmp_ge_u32 s6, 6
    s_cbranch_scc1 L_gu_7_82
    ds_read_b128 v[20:23], v4 offset:0
    ds_read_b128 v[24:27], v4 offset:64
    ds_read_b128 v[28:31], v4 offset:128
    s_cmp_lg_u32 s7, 0
    s_cbranch_scc1 L_gu_pf_84
    ds_read_b64_tr_b16 v[96:97], v64 offset:0
    ds_read_b64_tr_b16 v[98:99], v64 offset:1536
    ds_read_b64_tr_b16 v[100:101], v64 offset:3072
    ds_read_b64_tr_b16 v[102:103], v64 offset:4608
    ds_read_b64_tr_b16 v[104:105], v64 offset:6144
L_gu_pf_84:
    s_waitcnt lgkmcnt(0)
    v_mfma_f32_16x16x32_bf16 v[36:39], v[96:99], v[20:23], 0
    v_mfma_f32_16x16x32_bf16 v[36:39], v[100:103], v[24:27], v[36:39]
    v_mfma_f32_16x16x32_bf16 v[36:39], v[104:107], v[28:31], v[36:39]
    s_mov_b64 exec, s[40:41]
    s_cmp_eq_u32 s46, 0
    s_cbranch_scc1 L_slow_85
    s_nop 0
    s_nop 3
    buffer_store_dwordx4 v[36:39], v18, s[8:11], s51 offen
L_sd_86:
    s_mov_b64 exec, -1
    s_branch L_gu_s_81
L_gu_7_82:
    s_cmp_lg_u32 s6, 7
    s_cbranch_scc1 L_gu_s_81
    ds_read_b128 v[20:23], v4 offset:0
    ds_read_b128 v[24:27], v4 offset:64
    ds_read_b128 v[28:31], v4 offset:128
    v_mov_b32 v42, s44
    s_waitcnt lgkmcnt(0)
    v_mfma_f32_16x16x32_bf16 v[36:39], v[20:23], v[20:23], 0
    v_mfma_f32_16x16x32_bf16 v[36:39], v[24:27], v[24:27], v[36:39]
    v_mfma_f32_16x16x32_bf16 v[36:39], v[28:31], v[28:31], v[36:39]
    s_mov_b64 exec, 1
    s_cmp_eq_u32 s46, 0
    s_cbranch_scc1 L_slow_87
    s_nop 4
    buffer_store_dwordx2 v[36:37], v42, s[8:11], s51 offen offset:768
L_sd_88:
    s_mov_b64 exec, -1
L_gu_s_81:
    s_cmp_lt_u32 s6, 6
    s_cbranch_scc1 L_gg_pf_90
    s_sleep 5
    s_cmp_lg_u32 s7, 0
    s_cbranch_scc1 L_gg_p1_91
    buffer_load_dwordx4 v[20:23], v12, s[8:11], s51 offen offset:0 sc1
    buffer_load_dwordx4 v[24:27], v12, s[8:11], s51 offen offset:192 sc1
    buffer_load_dwordx4 v[28:31], v12, s[8:11], s51 offen offset:384 sc1
    buffer_load_dwordx4 v[32:35], v12, s[8:11], s51 offen offset:576 sc1
    buffer_load_dwordx2 v[36:37], v10, s[8:11], s51 offen offset:768 sc1
L_gg_w_93:
    s_nop 0
    s_waitcnt vmcnt(0)
    v_max3_u32 v38, v20, v21, v22
    v_max3_u32 v38, v38, v23, v24
    v_max3_u32 v38, v38, v25, v26
    v_max3_u32 v38, v38, v27, v28
    v_max3_u32 v38, v38, v29, v30
    v_max3_u32 v38, v38, v31, v32
    v_max3_u32 v38, v38, v33, v34
    v_max3_u32 v38, v38, v35, v36
    v_max_u32 v38, v38, v37
    v_cmp_eq_u32 vcc, -1, v38
    s_cmp_lg_u64 vcc, 0
    s_cbranch_scc1 L_gg_r_94
    v_permlane32_swap_b32 v28, v29
    v_permlane32_swap_b32 v30, v31
    v_add_f32 v28, v28, v29
    v_add_f32 v30, v30, v31
    s_nop 1
    v_permlane16_swap_b32 v28, v30
    v_add_f32 v15, v28, v30
    s_nop 1
    v_add_f32_dpp v15, v15, v15 row_ror:8 row_mask:0xf bank_mask:0xf
    v_permlane32_swap_b32 v32, v33
    v_permlane32_swap_b32 v34, v35
    v_add_f32 v32, v32, v33
    v_add_f32 v34, v34, v35
    s_nop 1
    v_permlane16_swap_b32 v32, v34
    v_add_f32 v16, v32, v34
    s_nop 1
    v_add_f32_dpp v16, v16, v16 row_ror:8 row_mask:0xf bank_mask:0xf
    v_permlane32_swap_b32 v20, v21
    v_permlane32_swap_b32 v22, v23
    v_permlane32_swap_b32 v24, v25
    v_permlane32_swap_b32 v26, v27
    v_add_f32_dpp v36, v36, v36 quad_perm:[1,0,3,2] row_mask:0xf bank_mask:0xf
    v_add_f32_dpp v37, v37, v37 quad_perm:[1,0,3,2] row_mask:0xf bank_mask:0xf
    v_add_f32 v20, v20, v21
    v_add_f32 v22, v22, v23
    v_add_f32 v24, v24, v25
    v_add_f32 v26, v26, v27
    v_add_f32_dpp v36, v36, v36 quad_perm:[2,3,0,1] row_mask:0xf bank_mask:0xf
    v_add_f32_dpp v37, v37, v37 quad_perm:[2,3,0,1] row_mask:0xf bank_mask:0xf
    v_permlane16_swap_b32 v20, v22
    v_permlane16_swap_b32 v24, v26
    v_add_f32_dpp v36, v36, v36 row_half_mirror row_mask:0xf bank_mask:0xf
    v_add_f32_dpp v37, v37, v37 row_half_mirror row_mask:0xf bank_mask:0xf
    v_add_f32 v39, v20, v22
    v_add_f32 v40, v24, v26
    v_mul_f32 v41, 0x3acccccd, v37
    v_mul_f32 v43, 0x3acccccd, v36
    v_add_f32_dpp v39, v39, v39 row_ror:8 row_mask:0xf bank_mask:0xf
    v_add_f32_dpp v40, v40, v40 row_ror:8 row_mask:0xf bank_mask:0xf
    v_fma_f32 v43, -v41, v41, v43
    v_max_f32_e64 v43, 0, v43
    v_add_f32 v43, 0x3727c5ac, v43
    v_fma_f32 v39, -v41, v15, v39
    v_fma_f32 v40, -v41, v16, v40
    v_rcp_f32 v42, v43
    v_mul_f32 v39, v39, v40
    v_mul_f32_e64 v39, v39, v42
    v_cvt_pk_bf16_f32 v39, v39, v39
    ds_write_b16 v69, v39
    s_branch L_gg_j_92
L_gg_p1_91:
    buffer_load_dwordx4 v[20:23], v12, s[8:11], s51 offen offset:0 sc1
    buffer_load_dwordx4 v[24:27], v12, s[8:11], s51 offen offset:192 sc1
    buffer_load_dwordx2 v[36:37], v10, s[8:11], s51 offen offset:768 sc1
L_gg_w_95:
    s_waitcnt vmcnt(0)
    v_max3_u32 v38, v20, v21, v22
    v_max3_u32 v38, v38, v23, v24
    v_max3_u32 v38, v38, v25, v26
    v_max3_u32 v38, v38, v27, v36
    v_max_u32 v38, v38, v37
    v_cmp_eq_u32 vcc, -1, v38
    s_cmp_lg_u64 vcc, 0
    s_cbranch_scc1 L_gg_r_96
    v_permlane32_swap_b32 v20, v21
    v_permlane32_swap_b32 v22, v23
    v_permlane32_swap_b32 v24, v25
    v_permlane32_swap_b32 v26, v27
    v_add_f32_dpp v36, v36, v36 quad_perm:[1,0,3,2] row_mask:0xf bank_mask:0xf
    v_add_f32_dpp v37, v37, v37 quad_perm:[1,0,3,2] row_mask:0xf bank_mask:0xf
    v_add_f32 v20, v20, v21
    v_add_f32 v22, v22, v23
    v_add_f32 v24, v24, v25
    v_add_f32 v26, v26, v27
    v_add_f32_dpp v36, v36, v36 quad_perm:[2,3,0,1] row_mask:0xf bank_mask:0xf
    v_add_f32_dpp v37, v37, v37 quad_perm:[2,3,0,1] row_mask:0xf bank_mask:0xf
    v_permlane16_swap_b32 v20, v22
    v_permlane16_swap_b32 v24, v26
    v_add_f32_dpp v36, v36, v36 row_half_mirror row_mask:0xf bank_mask:0xf
    v_add_f32_dpp v37, v37, v37 row_half_mirror row_mask:0xf bank_mask:0xf
    v_add_f32 v39, v20, v22
    v_add_f32 v40, v24, v26
    v_mul_f32 v41, 0x3acccccd, v37
    v_mul_f32 v43, 0x3acccccd, v36
    v_add_f32_dpp v39, v39, v39 row_ror:8 row_mask:0xf bank_mask:0xf
    v_add_f32_dpp v40, v40, v40 row_ror:8 row_mask:0xf bank_mask:0xf
    v_fma_f32 v43, -v41, v41, v43
    v_max_f32_e64 v43, 0, v43
    v_add_f32 v43, 0x3727c5ac, v43
    v_fma_f32 v39, -v41, v15, v39
    v_fma_f32 v40, -v41, v16, v40
    v_rcp_f32 v42, v43
    v_mul_f32 v39, v39, v40
    v_mul_f32_e64 v39, v39, v42
    v_cvt_pk_bf16_f32 v39, v39, v39
    ds_write_b16 v69, v39
    s_branch L_gg_j_92
L_gg_pf_90:
    s_cmp_ge_u32 s6, 5
    s_cbranch_scc1 L_gg_j_92
    v_lshrrev_b32 v65, 2, v3
    v_lshl_add_u32 v65, v2, 2, v65
    v_mul_u32_u24 v64, 160, v65
    v_and_b32_e64 v66, 3, v3
    v_lshl_add_u32 v64, v66, 3, v64
    s_lshl_b32 s54, s6, 5
    s_add_u32 s54, s54, 16384
    v_add_u32 v64, s54, v64
    ds_read_b64_tr_b16 v[96:97], v64 offset:0
    ds_read_b64_tr_b16 v[98:99], v64 offset:2560
    ds_read_b64_tr_b16 v[100:101], v64 offset:5120
    v_mov_b32 v102, 0
    v_mov_b32 v103, 0
L_gg_j_92:
    s_waitcnt lgkmcnt(0)
    s_barrier
    s_cmp_ge_u32 s6, 5
    s_cbranch_scc1 L_d_s_97
    ds_read_b128 v[20:23], v70 offset:0
    ds_read_b128 v[24:27], v70 offset:64
    s_waitcnt lgkmcnt(0)
    v_mfma_f32_16x16x32_bf16 v[36:39], v[96:99], v[20:23], 0
    v_mfma_f32_16x16x32_bf16 v[36:39], v[100:103], v[24:27], v[36:39]
    s_mov_b64 exec, s[32:33]
    s_nop 0
    s_nop 5
    buffer_store_dwordx4 v[36:39], v8, s[8:11], s53 offen sc1
    s_mov_b64 exec, -1
L_d_s_97:
    s_cmp_eq_u32 s7, 1
    s_cbranch_scc1 L_fin_98
    s_add_u32 s28, s82, s62
    s_addc_u32 s29, s83, 0
    s_sub_u32 s30, 1280, s62
    s_mov_b32 s31, 0x20000
    s_cmp_lg_u32 s2, 0
    s_cbranch_scc1 L_ep_99
    s_cmp_lg_u32 s6, 5
    s_cbranch_scc1 L_ep_99
    v_mov_b32 v40, s63
    v_mov_b32 v41, 0x3f0000
    s_mov_b64 exec, 1
    buffer_store_dword v40, v41, s[8:11], 0 offen
    s_mov_b64 exec, -1
L_ep_99:
    s_mov_b32 s3, s53
    s_mov_b32 s7, 1
    s_mul_i32 s49, s7, 3328
    s_lshl_b32 s50, s7, 9
    s_add_u32 s50, s50, 4224
    s_lshl_b32 s51, s7, 10
    s_add_u32 s51, s51, 5248
    s_mul_i32 s52, s7, 163840
    s_add_u32 s53, s52, 81920
    s_cmp_eq_u32 s7, 0
    s_cselect_b64 s[40:41], s[34:35], s[32:33]
    s_cmp_ge_u32 s6, 5
    s_cbranch_scc1 L_pair
    s_nop 0
    s_sleep 11
    buffer_load_dwordx4 v[20:23], v6, s[8:11], s3 offen sc1
    buffer_load_dwordx4 v[24:27], v6, s[8:11], s3 offen offset:1024 sc1
L_x_w_100:
    s_nop 0
    s_waitcnt vmcnt(0)
    v_max3_u32 v31, v20, v21, v22
    v_add_f32 v32, v20, v24
    v_add_f32 v33, v21, v25
    v_add_f32 v34, v22, v26
    v_add_f32 v35, v23, v27
    v_max3_u32 v31, v31, v23, v24
    v_add_f32_dpp v28, v32, v32 row_ror:8 row_mask:0xf bank_mask:0x3
    v_add_f32_dpp v29, v34, v34 row_ror:8 row_mask:0xf bank_mask:0x3
    v_add_f32_dpp v28, v33, v33 row_ror:8 row_mask:0xf bank_mask:0xc
    v_add_f32_dpp v29, v35, v35 row_ror:8 row_mask:0xf bank_mask:0xc
    v_max3_u32 v31, v31, v25, v26
    v_max_u32_e64 v31, v31, v27
    v_add_f32_dpp v30, v28, v28 row_shl:4 row_mask:0xf bank_mask:0x5
    v_add_f32_dpp v30, v29, v29 row_shr:4 row_mask:0xf bank_mask:0xa
    v_cmp_eq_u32_e64 vcc, -1, v31
    s_cmp_lg_u64 vcc, 0
    s_cbranch_scc1 L_x_r_101
    v_add_f32_dpp v30, v30, v30 quad_perm:[1,0,3,2] row_mask:0xf bank_mask:0xf
    s_nop 0
    s_nop 0
    v_add_f32_dpp v30, v30, v30 quad_perm:[2,3,0,1] row_mask:0xf bank_mask:0xf
    v_add_f32 v30, v30, v13
    s_branch L_pair2
L_fin_98:
    s_cmp_lg_u32 s4, 0
    s_cbranch_scc1 L_dump
    s_cmp_ge_u32 s6, 5
    s_cbranch_scc1 L_dump
    v_mov_b32 v40, v11
    s_sleep 11
    buffer_load_dwordx4 v[20:23], v6, s[8:11], s53 offen sc1
    buffer_load_dwordx4 v[24:27], v6, s[8:11], s53 offen offset:1024 sc1
L_x_w_102:
    s_nop 0
    s_waitcnt vmcnt(0)
    v_max3_u32 v31, v20, v21, v22
    v_add_f32 v32, v20, v24
    v_add_f32 v33, v21, v25
    v_add_f32 v34, v22, v26
    v_add_f32 v35, v23, v27
    v_max3_u32 v31, v31, v23, v24
    v_add_f32_dpp v28, v32, v32 row_ror:8 row_mask:0xf bank_mask:0x3
    v_add_f32_dpp v29, v34, v34 row_ror:8 row_mask:0xf bank_mask:0x3
    v_add_f32_dpp v28, v33, v33 row_ror:8 row_mask:0xf bank_mask:0xc
    v_add_f32_dpp v29, v35, v35 row_ror:8 row_mask:0xf bank_mask:0xc
    v_max3_u32 v31, v31, v25, v26
    v_max_u32_e64 v31, v31, v27
    v_add_f32_dpp v30, v28, v28 row_shl:4 row_mask:0xf bank_mask:0x5
    v_add_f32_dpp v30, v29, v29 row_shr:4 row_mask:0xf bank_mask:0xa
    v_cmp_eq_u32_e64 vcc, -1, v31
    s_cmp_lg_u64 vcc, 0
    s_cbranch_scc1 L_x_r_103
    v_add_f32_dpp v30, v30, v30 quad_perm:[1,0,3,2] row_mask:0xf bank_mask:0xf
    s_nop 0
    s_nop 0
    v_add_f32_dpp v30, v30, v30 quad_perm:[2,3,0,1] row_mask:0xf bank_mask:0xf
    v_add_f32_e64 v30, v30, v13
    v_cvt_pk_bf16_f32 v30, v30, v30
    s_mov_b64 exec, s[36:37]
    buffer_store_short v30, v40, s[28:31], 0 offen
    s_mov_b64 exec, -1
L_dump:
L_end:
    s_endpgm
L_qg1r_48:
    buffer_load_dwordx4 v[20:23], v9, s[8:11], s49 offen sc1
    s_add_u32 s54, s49, 32768
    buffer_load_dwordx4 v[24:27], v9, s[8:11], s54 offen sc1
    buffer_load_dwordx2 v[28:29], v10, s[8:11], s49 offen offset:768 sc1
    s_add_u32 s47, s47, 1
    s_cmp_lt_u32 s47, 0x40000
    s_cbranch_scc1 L_qg1w_47
    s_branch L_end
L_o_r_65:
    buffer_load_dwordx4 v[20:23], v0, s[8:11], s50 offen sc1
    buffer_load_dwordx2 v[24:25], v156, s[8:11], s50 offen offset:384 sc1
    s_add_u32 s47, s47, 1
    s_cmp_lt_u32 s47, 0x40000
    s_cbranch_scc1 L_o_w_64
    s_branch L_end
L_x_r_80:
    buffer_load_dwordx4 v[20:23], v6, s[8:11], s52 offen sc1
    buffer_load_dwordx4 v[24:27], v6, s[8:11], s52 offen offset:1024 sc1
    s_add_u32 s47, s47, 1
    s_cmp_lt_u32 s47, 0x40000
    s_cbranch_scc1 L_x_w_79
    s_branch L_end
L_gg_r_94:
    buffer_load_dwordx4 v[20:23], v12, s[8:11], s51 offen offset:0 sc1
    buffer_load_dwordx4 v[24:27], v12, s[8:11], s51 offen offset:192 sc1
    buffer_load_dwordx4 v[28:31], v12, s[8:11], s51 offen offset:384 sc1
    buffer_load_dwordx4 v[32:35], v12, s[8:11], s51 offen offset:576 sc1
    buffer_load_dwordx2 v[36:37], v10, s[8:11], s51 offen offset:768 sc1
    s_add_u32 s47, s47, 1
    s_cmp_lt_u32 s47, 0x40000
    s_cbranch_scc1 L_gg_w_93
    s_branch L_end
L_gg_r_96:
    buffer_load_dwordx4 v[20:23], v12, s[8:11], s51 offen offset:0 sc1
    buffer_load_dwordx4 v[24:27], v12, s[8:11], s51 offen offset:192 sc1
    buffer_load_dwordx2 v[36:37], v10, s[8:11], s51 offen offset:768 sc1
    s_add_u32 s47, s47, 1
    s_cmp_lt_u32 s47, 0x40000
    s_cbranch_scc1 L_gg_w_95
    s_branch L_end
L_x_r_101:
    buffer_load_dwordx4 v[20:23], v6, s[8:11], s3 offen sc1
    buffer_load_dwordx4 v[24:27], v6, s[8:11], s3 offen offset:1024 sc1
    s_add_u32 s47, s47, 1
    s_cmp_lt_u32 s47, 0x40000
    s_cbranch_scc1 L_x_w_100
    s_branch L_end
L_x_r_103:
    buffer_load_dwordx4 v[20:23], v6, s[8:11], s53 offen sc1
    buffer_load_dwordx4 v[24:27], v6, s[8:11], s53 offen offset:1024 sc1
    s_add_u32 s47, s47, 1
    s_cmp_lt_u32 s47, 0x40000
    s_cbranch_scc1 L_x_w_102
    s_branch L_end
L_slow_43:
    s_nop 0
    s_nop 6
    buffer_store_dwordx4 v[36:39], v17, s[8:11], s49 offen  sc1
    buffer_store_dwordx4 v[40:43], v17, s[8:11], s49 offen offset:64 sc1
    buffer_store_dwordx4 v[44:47], v17, s[8:11], s49 offen offset:128 sc1
    s_branch L_sd_44
L_slow_45:
    s_nop 7
    buffer_store_dwordx2 v[36:37], v42, s[8:11], s49 offen offset:768 sc1
    s_branch L_sd_46
L_slow_85:
    s_nop 7
    buffer_store_dwordx4 v[36:39], v18, s[8:11], s51 offen  sc1
    s_branch L_sd_86
L_slow_87:
    s_nop 7
    buffer_store_dwordx2 v[36:37], v42, s[8:11], s51 offen offset:768 sc1
    s_branch L_sd_88
L_slow_59:
    buffer_store_dwordx2 v[22:23], v72, s[8:11], s50 offen  sc1
    s_branch L_sd_60
L_slow_61:
    buffer_store_dwordx2 v[20:21], v33, s[8:11], s50 offen offset:384 sc1
    s_branch L_sd_62
.section .rodata,"a"
.p2align 6
.amdhsa_kernel interleave_layers__sliding_block_cached__glu_gated_bilinear__decode_kernel
  .amdhsa_next_free_vgpr 256
  .amdhsa_next_free_sgpr 102
  .amdhsa_accum_offset 256
  .amdhsa_group_segment_fixed_size 0
  .amdhsa_kernarg_size 96
  .amdhsa_user_sgpr_count 2
  .amdhsa_user_sgpr_kernarg_segment_ptr 1
  .amdhsa_system_sgpr_workgroup_id_x 1
.end_amdhsa_kernel
```
